```python
import torch

def _softmax(x, axis=-1):
    return torch.softmax(x, dim=axis)
def _gelu(x):
    return torch.nn.functional.gelu(x, approximate="tanh")
def _silu(x):
    return torch.nn.functional.silu(x)
def _sigmoid(x):
    return torch.sigmoid(x)
def _layernorm(x, axis=-1, eps=1e-5):
    m = x.mean(dim=axis, keepdim=True)
    v = x.var(dim=axis, keepdim=True, unbiased=False)
    return (x - m) / torch.sqrt(v + eps)
def _scatter_add(tgt, idx, src, axis=0):
    return tgt.clone().index_add_(axis, idx, src)
def _segment_sum(src, seg, n):
    out = torch.zeros((n,) + src.shape[1:], dtype=src.dtype)
    return out.index_add_(0, seg, src)
def _pad(x, pw):
    flat = tuple(v for pair in reversed(pw) for v in pair)
    return torch.nn.functional.pad(x, flat)

kernel_name = 'sequential_preLN__ssm_conv_h3__glu_gated_swiglu__prompt'

def setup_inputs():

    _w = (lambda a: (lambda t: t.to(torch.bfloat16) if t.is_floating_point() else t)(torch.as_tensor(a)))
    def _A_setup():
        B, S, D = 1, 2048, 512
        ks = 4
        return {
            "q": _w((lambda *s: torch.randn(*s, dtype=torch.bfloat16) * 0.05)(B, S, D)),
            "k": _w((lambda *s: torch.randn(*s, dtype=torch.bfloat16) * 0.2)(B, S, D)),
            "v": _w((lambda *s: torch.randn(*s, dtype=torch.bfloat16) * 0.2)(B, S, D)),
            "shift_k": _w((lambda *s: torch.randn(*s, dtype=torch.bfloat16) * 0.2)(D, ks) * 0.5),
            "ssm_k": _w((lambda *s: torch.randn(*s, dtype=torch.bfloat16) * 0.4)(D, S) * (1.0 / S ** 0.5)),
            "ssm_D": _w((lambda *s: torch.randn(*s, dtype=torch.bfloat16) * 0.2)(D)),
        }
    _A_in = _A_setup()

    def _B_setup():
        B, S, D, F = 1, 2048, 512, 1792
        return {
            "x": _w((lambda *s: torch.randn(*s, dtype=torch.bfloat16) * 0.05)(B, S, D)),
            "w1": _w((lambda *s: torch.randn(*s, dtype=torch.bfloat16) * 0.2)(D, F) * (2.0 / D) ** 0.5),
            "w3": _w((lambda *s: torch.randn(*s, dtype=torch.bfloat16) * 0.2)(D, F) * (2.0 / D) ** 0.5),
            "w2": _w((lambda *s: torch.randn(*s, dtype=torch.bfloat16) * 0.2)(F, D) * (2.0 / F) ** 0.5),
        }
    _B_in = _B_setup()

    return {
        "A_q": _A_in["q"],
        "A_k": _A_in["k"],
        "A_v": _A_in["v"],
        "A_shift_k": _A_in["shift_k"],
        "A_ssm_k": _A_in["ssm_k"],
        "A_ssm_D": _A_in["ssm_D"],
        "B_x": _B_in["x"],
        "B_w1": _B_in["w1"],
        "B_w3": _B_in["w3"],
        "B_w2": _B_in["w2"],
    }

def reference(A_q, A_k, A_v, A_shift_k, A_ssm_k, A_ssm_D, B_x, B_w1, B_w3, B_w2):
    def _A_ref(q, k, v, shift_k, ssm_k, ssm_D):
        B, S, D = q.shape
        ks = shift_k.shape[-1]
        k_pad = _pad(k, ((0, 0), (ks - 1, 0), (0, 0)))
        k_shift = torch.zeros_like(k)
        for t in range(ks):
            k_shift = k_shift + k_pad[:, t:t + S, :] * shift_k[:, ks - 1 - t][None, None, :]
        kv = k_shift * v
        L = 2 * S
        kv_pad = _pad(kv, ((0, 0), (0, S), (0, 0)))
        kf_pad = _pad(ssm_k, ((0, 0), (0, S)))
        kv_f = (lambda x, axes=(-2,-1): torch.fft.rfft2(x.float(), dim=axes))(kv_pad[:, None, :, :], axes=(1, 2))
        kf_f = (lambda x, axes=(-2,-1): torch.fft.rfft2(x.float(), dim=axes))(kf_pad[:, None, :], axes=(1, 2))
        kf_f = (lambda x, *d: x.permute(*d))(kf_f, 1, 2, 0)
        y_f = kv_f * kf_f[None, :, :, :]
        y = (lambda x, s, axes=(-2,-1): torch.fft.irfft2(x, s=s, dim=axes).to(torch.bfloat16))(y_f, (1, L), axes=(1, 2))[:, 0, :S, :]
        y = y + kv * ssm_D[None, None, :]
        return q * y

    def _B_ref(x, w1, w3, w2):
        gate = torch.einsum("bsd,df->bsf", x, w1)
        up = torch.einsum("bsd,df->bsf", x, w3)
        h = _silu(gate) * up
        out = torch.einsum("bsf,fd->bsd", h, w2)
        return out

    x = A_q
    h = x + _A_ref(_layernorm(x, axis=-1), A_k, A_v, A_shift_k, A_ssm_k, A_ssm_D)
    h2 = h + _B_ref(_layernorm(h, axis=-1), B_w1, B_w3, B_w2)
    return h2
```

```asm
; @launch grid=(256,1,1) block=(512,1,1) lds=163840
.amdgcn_target "amdgcn-amd-amdhsa--gfx950"
.text
.globl sequential_preLN__ssm_conv_h3__glu_gated_swiglu__prompt_kernel
.p2align 8
.type sequential_preLN__ssm_conv_h3__glu_gated_swiglu__prompt_kernel,@function
sequential_preLN__ssm_conv_h3__glu_gated_swiglu__prompt_kernel:
    s_cmp_ge_u32 s2, 256
    s_cbranch_scc0 k_go
    s_endpgm
k_go:
    s_load_dwordx2 s[28:29], s[0:1], 8
    s_load_dwordx2 s[36:37], s[0:1], 24
    s_load_dwordx2 s[32:33], s[0:1], 16
    s_load_dwordx2 s[24:25], s[0:1], 0
    v_lshrrev_b32 v1, 6, v0
    v_and_b32 v2, 63, v0
    v_readfirstlane_b32 s3, v1
    s_and_b32 s66, s2, 7
    s_lshr_b32 s67, s2, 3
    s_cmp_ge_u32 s3, 4
    s_cbranch_scc1 k_hi
    s_mov_b32 s30, 0x200000
    s_mov_b32 s31, 0x20000
    s_lshl_b32 s75, s67, 16
    s_lshl_b32 s76, s66, 7
    s_add_u32 s75, s75, s76
    v_lshrrev_b32 v4, 3, v0
    v_and_b32 v5, 7, v0
    v_lshlrev_b32 v6, 11, v4
    v_lshl_add_u32 v6, v5, 4, v6
    v_add_u32 v6, s75, v6
    s_movk_i32 s38, 4096
    s_mov_b32 s39, s31
    s_mov_b64 s[34:35], s[30:31]
    s_mov_b64 s[26:27], s[30:31]
    v_subrev_u32 v7, 3072, v6
    v_subrev_u32 v8, 2048, v6
    v_subrev_u32 v9, 1024, v6
    s_lshl_b32 s76, s66, 9
    v_lshlrev_b32 v10, 6, v5
    s_waitcnt lgkmcnt(0)
    buffer_load_dwordx4 v[52:55], v10, s[36:39], s76 offen offset:0
    buffer_load_dwordx4 v[56:59], v10, s[36:39], s76 offen offset:16
    buffer_load_dwordx4 v[60:63], v10, s[36:39], s76 offen offset:32
    buffer_load_dwordx4 v[64:67], v10, s[36:39], s76 offen offset:48
    buffer_load_dwordx4 v[16:19], v7, s[28:31], 0 offen nt
    buffer_load_dwordx4 v[20:23], v8, s[28:31], 0 offen nt
    buffer_load_dwordx4 v[24:27], v9, s[28:31], 0 offen nt
    buffer_load_dwordx4 v[28:31], v6, s[28:31], 0 offen nt
    buffer_load_dwordx4 v[32:35], v6, s[28:31], 0 offen offset:1024 nt
    buffer_load_dwordx4 v[36:39], v6, s[32:35], 0 offen offset:0 nt
    buffer_load_dwordx4 v[40:43], v6, s[32:35], 0 offen offset:1024 nt
    buffer_load_dwordx4 v[44:47], v6, s[24:27], 0 offen offset:0 nt
    buffer_load_dwordx4 v[48:51], v6, s[24:27], 0 offen offset:1024 nt
    s_load_dwordx16 s[48:63], s[0:1], 32
    s_load_dwordx2 s[64:65], s[0:1], 96
    s_getreg_b32 s68, hwreg(HW_REG_XCC_ID, 0, 4)
    v_lshlrev_b32 v3, 4, v2
    s_and_b32 s68, s68, 7
    s_add_u32 s68, s68, 1
    s_mov_b32 s72, 0xffff0000
    s_mov_b32 s70, 0
    s_and_b32 s73, s3, 3
    s_lshl_b32 s75, s66, 6
    s_lshl_b32 s76, s67, 1
    s_add_u32 s75, s75, s76
    s_and_b32 s76, s3, 1
    s_add_u32 s75, s75, s76
    s_lshl_b32 s74, s75, 12
    s_waitcnt lgkmcnt(0)
    s_mov_b32 s4, s64
    s_and_b32 s5, s65, 0xffff
    s_mov_b32 s6, 0x1000000
    s_mov_b32 s7, 0x20000
    s_mov_b32 s8, s62
    s_and_b32 s9, s63, 0xffff
    s_mov_b32 s10, 0x100
    s_mov_b32 s11, 0x20000
    s_mov_b32 s16, s58
    s_and_b32 s17, s59, 0xffff
    s_mov_b32 s18, 0x1c0000
    s_mov_b32 s19, 0x20000
    s_mov_b32 s20, s60
    s_and_b32 s21, s61, 0xffff
    s_mov_b32 s22, 0x200000
    s_mov_b32 s23, 0x20000
    s_cmp_eq_u32 s3, 0
    s_cbranch_scc0 l_pub1
    s_lshl_b32 s75, s66, 5
    s_add_u32 s75, s75, s67
    v_mov_b32 v12, s68
    v_mov_b32 v13, 0
    v_mov_b32 v14, 0
    v_mov_b32 v15, 159232
    s_mov_b64 exec, 1
    buffer_store_byte v12, v13, s[8:11], s75 offen
    ds_write2_b32 v15, v13, v14 offset0:0 offset1:1
    ds_write2_b32 v15, v13, v14 offset0:2 offset1:3
    ds_write2_b32 v15, v13, v14 offset0:4 offset1:5
    ds_write2_b32 v15, v13, v14 offset0:6 offset1:7
    s_mov_b64 exec, -1
    s_waitcnt lgkmcnt(0)
l_pub1:
    s_barrier
    s_mov_b32 s75, 6406144
    s_load_dword s69, s[64:65], s75
    s_lshr_b32 s76, s74, 11
    s_and_b32 s76, s76, 0xfffc
    s_load_dword s71, s[50:51], s76
    v_lshlrev_b32 v12, 1, v4
    v_sub_u32 v13, 62, v12
    v_mul_u32_u24 v13, 144, v13
    v_lshl_add_u32 v13, v5, 4, v13
    v_add_u32 v13, 139776, v13
    v_mul_u32_u24 v14, 144, v12
    v_lshl_add_u32 v14, v5, 4, v14
    v_add_u32 v14, 148992, v14
    v_lshrrev_b32 v4, 4, v2
    v_and_b32 v5, 15, v2
    v_lshrrev_b32 v7, 2, v5
    v_lshl_add_u32 v7, v4, 3, v7
    v_bfe_u32 v8, v5, 1, 1
    v_lshl_add_u32 v7, v8, 5, v7
    v_mul_u32_u24 v7, 144, v7
    v_and_b32 v8, 1, v5
    v_lshl_add_u32 v7, v8, 3, v7
    s_lshl_b32 s75, s3, 5
    s_add_u32 s75, s75, 139776
    v_add_u32 v7, s75, v7
    s_lshl_b32 s75, s66, 6
    s_lshl_b32 s76, s3, 4
    s_add_u32 s75, s75, s76
    v_and_b32 v8, 7, v5
    v_add_u32 v8, s75, v8
    v_lshlrev_b32 v8, 12, v8
    v_lshl_add_u32 v8, v4, 4, v8
    v_lshrrev_b32 v9, 3, v5
    v_lshl_add_u32 v8, v9, 6, v8
    v_add_u32 v15, 32768, v8
    s_lshl_b32 s75, s67, 7
    s_sub_u32 s40, 3968, s75
    s_add_u32 s41, s75, 2097152
    s_lshl_b32 s42, s66, 5
    v_and_b32 v9, 31, v2
    s_waitcnt vmcnt(9)
    v_lshlrev_b32 v68, 16, v52
    v_and_b32 v76, s72, v52
    v_lshlrev_b32 v84, 16, v53
    v_and_b32 v92, s72, v53
    v_lshlrev_b32 v69, 16, v54
    v_and_b32 v77, s72, v54
    v_lshlrev_b32 v85, 16, v55
    v_and_b32 v93, s72, v55
    v_lshlrev_b32 v70, 16, v56
    v_and_b32 v78, s72, v56
    v_lshlrev_b32 v86, 16, v57
    v_and_b32 v94, s72, v57
    v_lshlrev_b32 v71, 16, v58
    v_and_b32 v79, s72, v58
    v_lshlrev_b32 v87, 16, v59
    v_and_b32 v95, s72, v59
    v_lshlrev_b32 v72, 16, v60
    v_and_b32 v80, s72, v60
    v_lshlrev_b32 v88, 16, v61
    v_and_b32 v96, s72, v61
    v_lshlrev_b32 v73, 16, v62
    v_and_b32 v81, s72, v62
    v_lshlrev_b32 v89, 16, v63
    v_and_b32 v97, s72, v63
    v_lshlrev_b32 v74, 16, v64
    v_and_b32 v82, s72, v64
    v_lshlrev_b32 v90, 16, v65
    v_and_b32 v98, s72, v65
    v_lshlrev_b32 v75, 16, v66
    v_and_b32 v83, s72, v66
    v_lshlrev_b32 v91, 16, v67
    v_and_b32 v99, s72, v67
    s_waitcnt vmcnt(4)
    v_lshlrev_b32 v100, 16, v16
    v_and_b32 v101, s72, v16
    v_lshlrev_b32 v102, 16, v17
    v_and_b32 v103, s72, v17
    v_lshlrev_b32 v104, 16, v18
    v_and_b32 v105, s72, v18
    v_lshlrev_b32 v106, 16, v19
    v_and_b32 v107, s72, v19
    v_lshlrev_b32 v108, 16, v20
    v_and_b32 v109, s72, v20
    v_lshlrev_b32 v110, 16, v21
    v_and_b32 v111, s72, v21
    v_lshlrev_b32 v112, 16, v22
    v_and_b32 v113, s72, v22
    v_lshlrev_b32 v114, 16, v23
    v_and_b32 v115, s72, v23
    v_lshlrev_b32 v116, 16, v24
    v_and_b32 v117, s72, v24
    v_lshlrev_b32 v118, 16, v25
    v_and_b32 v119, s72, v25
    v_lshlrev_b32 v120, 16, v26
    v_and_b32 v121, s72, v26
    v_lshlrev_b32 v122, 16, v27
    v_and_b32 v123, s72, v27
    v_lshlrev_b32 v124, 16, v28
    v_and_b32 v125, s72, v28
    v_lshlrev_b32 v126, 16, v29
    v_and_b32 v127, s72, v29
    v_lshlrev_b32 v128, 16, v30
    v_and_b32 v129, s72, v30
    v_lshlrev_b32 v130, 16, v31
    v_and_b32 v131, s72, v31
    v_lshlrev_b32 v132, 16, v32
    v_and_b32 v133, s72, v32
    v_lshlrev_b32 v134, 16, v33
    v_and_b32 v135, s72, v33
    v_lshlrev_b32 v136, 16, v34
    v_and_b32 v137, s72, v34
    v_lshlrev_b32 v138, 16, v35
    v_and_b32 v139, s72, v35
    v_pk_mul_f32 v[16:17], v[100:101], v[92:93]
    v_pk_mul_f32 v[18:19], v[102:103], v[94:95]
    v_pk_mul_f32 v[20:21], v[104:105], v[96:97]
    v_pk_mul_f32 v[22:23], v[106:107], v[98:99]
    v_pk_mul_f32 v[24:25], v[108:109], v[92:93]
    v_pk_mul_f32 v[26:27], v[110:111], v[94:95]
    v_pk_mul_f32 v[28:29], v[112:113], v[96:97]
    v_pk_mul_f32 v[30:31], v[114:115], v[98:99]
    v_pk_fma_f32 v[16:17], v[108:109], v[84:85], v[16:17]
    v_pk_fma_f32 v[18:19], v[110:111], v[86:87], v[18:19]
    v_pk_fma_f32 v[20:21], v[112:113], v[88:89], v[20:21]
    v_pk_fma_f32 v[22:23], v[114:115], v[90:91], v[22:23]
    v_pk_fma_f32 v[24:25], v[116:117], v[84:85], v[24:25]
    v_pk_fma_f32 v[26:27], v[118:119], v[86:87], v[26:27]
    v_pk_fma_f32 v[28:29], v[120:121], v[88:89], v[28:29]
    v_pk_fma_f32 v[30:31], v[122:123], v[90:91], v[30:31]
    v_pk_fma_f32 v[16:17], v[116:117], v[76:77], v[16:17]
    v_pk_fma_f32 v[18:19], v[118:119], v[78:79], v[18:19]
    v_pk_fma_f32 v[20:21], v[120:121], v[80:81], v[20:21]
    v_pk_fma_f32 v[22:23], v[122:123], v[82:83], v[22:23]
    v_pk_fma_f32 v[24:25], v[124:125], v[76:77], v[24:25]
    v_pk_fma_f32 v[26:27], v[126:127], v[78:79], v[26:27]
    v_pk_fma_f32 v[28:29], v[128:129], v[80:81], v[28:29]
    v_pk_fma_f32 v[30:31], v[130:131], v[82:83], v[30:31]
    v_pk_fma_f32 v[16:17], v[124:125], v[68:69], v[16:17]
    v_pk_fma_f32 v[18:19], v[126:127], v[70:71], v[18:19]
    v_pk_fma_f32 v[20:21], v[128:129], v[72:73], v[20:21]
    v_pk_fma_f32 v[22:23], v[130:131], v[74:75], v[22:23]
    v_pk_fma_f32 v[24:25], v[132:133], v[68:69], v[24:25]
    v_pk_fma_f32 v[26:27], v[134:135], v[70:71], v[26:27]
    v_pk_fma_f32 v[28:29], v[136:137], v[72:73], v[28:29]
    v_pk_fma_f32 v[30:31], v[138:139], v[74:75], v[30:31]
    s_waitcnt vmcnt(2)
    v_lshlrev_b32 v140, 16, v36
    v_and_b32 v141, s72, v36
    v_lshlrev_b32 v142, 16, v37
    v_and_b32 v143, s72, v37
    v_lshlrev_b32 v144, 16, v38
    v_and_b32 v145, s72, v38
    v_lshlrev_b32 v146, 16, v39
    v_and_b32 v147, s72, v39
    v_lshlrev_b32 v148, 16, v40
    v_and_b32 v149, s72, v40
    v_lshlrev_b32 v150, 16, v41
    v_and_b32 v151, s72, v41
    v_lshlrev_b32 v152, 16, v42
    v_and_b32 v153, s72, v42
    v_lshlrev_b32 v154, 16, v43
    v_and_b32 v155, s72, v43
    v_pk_mul_f32 v[16:17], v[16:17], v[140:141]
    v_pk_mul_f32 v[18:19], v[18:19], v[142:143]
    v_pk_mul_f32 v[20:21], v[20:21], v[144:145]
    v_pk_mul_f32 v[22:23], v[22:23], v[146:147]
    v_pk_mul_f32 v[24:25], v[24:25], v[148:149]
    v_pk_mul_f32 v[26:27], v[26:27], v[150:151]
    v_pk_mul_f32 v[28:29], v[28:29], v[152:153]
    v_pk_mul_f32 v[30:31], v[30:31], v[154:155]
    v_cvt_pk_bf16_f32 v52, v16, v17
    v_cvt_pk_bf16_f32 v53, v18, v19
    v_cvt_pk_bf16_f32 v54, v20, v21
    v_cvt_pk_bf16_f32 v55, v22, v23
    v_cvt_pk_bf16_f32 v56, v24, v25
    v_cvt_pk_bf16_f32 v57, v26, v27
    v_cvt_pk_bf16_f32 v58, v28, v29
    v_cvt_pk_bf16_f32 v59, v30, v31
    ds_write_b128 v13, v[52:55] offset:144
    ds_write_b128 v13, v[56:59]
    s_waitcnt vmcnt(0)
    ds_write_b128 v14, v[44:47]
    ds_write_b128 v14, v[48:51] offset:144
    s_waitcnt lgkmcnt(0)
    v_mov_b32 v80, 159232
    v_mov_b32 v81, 1
    s_mov_b64 exec, 1
    ds_add_u32 v80, v81
    s_mov_b64 exec, -1
    s_and_b32 s69, s69, -4
    s_add_u32 s69, s69, 4
    s_lshr_b32 s75, s69, 2
    s_mul_i32 s75, s75, 0x9e3779b1
    s_bfe_u32 s32, s75, 0x80000
    s_bfe_u32 s33, s75, 0x80008
    s_bfe_u32 s34, s75, 0x80010
    s_bfe_u32 s35, s75, 0x80018
    s_and_b32 s75, s71, 0xffff0000
    s_lshl_b32 s76, s71, 16
    s_bitcmp1_b32 s3, 0
    s_cselect_b32 s71, s75, s76
    v_mov_b32 v80, 159232
    s_mov_b32 s77, 0
l_rv2:
    ds_read_b32 v82, v80
    s_add_u32 s77, s77, 1
    s_waitcnt lgkmcnt(0)
    v_readfirstlane_b32 s76, v82
    s_cmp_ge_u32 s77, 160000
    s_cbranch_scc1 l_rd3
    s_cmp_lt_u32 s76, 4
    s_cbranch_scc1 l_rv2
l_rd3:
    ds_read_b64_tr_b16 v[84:85], v7 offset:0
    ds_read_b64_tr_b16 v[86:87], v7 offset:576
    ds_read_b64_tr_b16 v[88:89], v7 offset:16
    ds_read_b64_tr_b16 v[90:91], v7 offset:592
    ds_read_b64_tr_b16 v[92:93], v7 offset:9216
    ds_read_b64_tr_b16 v[94:95], v7 offset:9792
    ds_read_b64_tr_b16 v[96:97], v7 offset:9232
    ds_read_b64_tr_b16 v[98:99], v7 offset:9808
    s_waitcnt lgkmcnt(6)
    buffer_store_dwordx4 v[84:87], v8, s[4:7], s40 offen
    s_waitcnt lgkmcnt(4)
    buffer_store_dwordx4 v[88:91], v15, s[4:7], s40 offen
    s_waitcnt lgkmcnt(2)
    buffer_store_dwordx4 v[92:95], v8, s[4:7], s41 offen
    s_waitcnt lgkmcnt(0)
    buffer_store_dwordx4 v[96:99], v15, s[4:7], s41 offen
    buffer_load_ubyte v10, v9, s[8:11], s42 offen sc1
    s_waitcnt vmcnt(0)
    v_and_b32 v10, 15, v10
    v_cmp_eq_u32 vcc, s68, v10
    s_nop 0
    s_cmp_eq_u32 vcc_lo, -1
    s_cselect_b32 s70, 1, 0
    s_mov_b32 s77, 0
l_ag5:
    s_cmp_eq_u32 s70, 0
    s_cbranch_scc0 l_nr4
    v_cmp_eq_u32 s[38:39], 0, v10
    s_add_u32 s77, s77, 1
    s_or_b32 s38, s38, vcc_lo
    s_cmp_eq_u32 s38, -1
    s_cbranch_scc0 l_fr6
    s_cmp_ge_u32 s77, 64
    s_cbranch_scc1 l_fr6
    buffer_load_ubyte v10, v9, s[8:11], s42 offen sc1
    s_waitcnt vmcnt(0)
    v_and_b32 v10, 15, v10
    v_cmp_eq_u32 vcc, s68, v10
    s_nop 0
    s_cmp_eq_u32 vcc_lo, -1
    s_cselect_b32 s70, 1, 0
    s_branch l_ag5
l_fr6:
    buffer_store_dwordx4 v[84:87], v8, s[4:7], s40 offen sc1
    buffer_store_dwordx4 v[88:91], v15, s[4:7], s40 offen sc1
    buffer_store_dwordx4 v[92:95], v8, s[4:7], s41 offen sc1
    buffer_store_dwordx4 v[96:99], v15, s[4:7], s41 offen sc1
    s_waitcnt vmcnt(0)
l_nr4:
    v_mov_b32 v80, 159236
    v_mov_b32 v81, 1
    s_mov_b64 exec, 1
    ds_add_u32 v80, v81
    s_mov_b64 exec, -1
    s_cmp_eq_u32 s3, 0
    s_cbranch_scc0 l_sig7
    v_mov_b32 v80, 159236
    s_mov_b32 s77, 0
l_rv8:
    ds_read_b32 v82, v80
    s_add_u32 s77, s77, 1
    s_waitcnt lgkmcnt(0)
    v_readfirstlane_b32 s76, v82
    s_cmp_ge_u32 s77, 160000
    s_cbranch_scc1 l_rd9
    s_cmp_lt_u32 s76, 4
    s_cbranch_scc1 l_rv8
l_rd9:
    s_lshl_b32 s75, s66, 5
    s_add_u32 s75, s75, s67
    s_or_b32 s76, s68, 16
    v_mov_b32 v104, s76
    v_mov_b32 v105, 0
    s_mov_b64 exec, 1
    buffer_store_byte v104, v105, s[8:11], s75 offen
    s_cmp_eq_u32 s70, 0
    s_cbranch_scc0 l_sg10
    s_lshl_b32 s75, s75, 7
    s_add_u32 s75, s75, 6356992
    s_add_u32 s76, s69, 1
    v_mov_b32 v106, s76
    buffer_store_dword v106, v105, s[4:7], s75 offen sc1
l_sg10:
    s_mov_b64 exec, -1
l_sig7:
    v_and_b32 v6, 15, v2
    v_lshrrev_b32 v7, 4, v2
    v_add_u32 v8, 1, v6
    v_and_b32 v9, 3, v8
    v_mul_u32_u24 v9, 4160, v9
    v_and_b32 v8, 28, v8
    v_lshl_add_u32 v9, v8, 1, v9
    v_lshl_add_u32 v9, v7, 4, v9
    s_and_b32 s62, s3, 1
    s_lshr_b32 s63, s73, 1
    s_lshl_b32 s61, s63, 6
    s_mul_i32 s75, s62, 16640
    s_add_u32 s75, s75, s61
    s_add_u32 s75, s75, 106496
    v_add_u32 v9, s75, v9
    s_mul_i32 s52, s62, 4608
    s_add_u32 s52, s52, 149632
    v_lshlrev_b32 v8, 4, v7
    v_lshlrev_b32 v10, 5, v6
    v_sub_u32 v8, v8, v10
    s_add_u32 s75, s52, s61
    s_add_u32 s75, s75, 480
    v_add_u32 v8, s75, v8
    s_mul_i32 s51, s62, 24576
    s_add_u32 s51, s51, 100480
    v_lshl_add_u32 v10, v7, 3, v10
    s_lshl_b32 s75, s63, 11
    s_add_u32 s50, s75, s74
    v_add_u32 v11, s50, v10
    s_sub_u32 s76, s52, s75
    s_add_u32 s76, s76, 2552
    v_sub_u32 v12, s76, v10
    v_lshlrev_b32 v13, 1, v10
    s_lshl_b32 s58, s63, 12
    s_add_u32 s58, s58, 6291456
    s_add_u32 s59, s58, 8192
    v_lshrrev_b32 v14, 2, v6
    v_lshrrev_b32 v15, 1, v7
    v_lshl_add_u32 v14, v15, 3, v14
    v_and_b32 v15, 1, v6
    v_bfe_u32 v152, v6, 1, 1
    v_lshl_add_u32 v15, v15, 1, v152
    v_lshlrev_b32 v15, 3, v15
    v_and_b32 v152, 1, v7
    v_lshl_add_u32 v15, v152, 5, v15
    v_lshrrev_b32 v152, 3, v6
    v_lshl_add_u32 v15, v152, 6, v15
    v_lshl_add_u32 v152, v14, 7, v15
    v_mov_b32 v112, 159240
    s_mov_b32 s77, 0
l_rv11:
    ds_read_b32 v114, v112
    s_add_u32 s77, s77, 1
    s_waitcnt lgkmcnt(0)
    v_readfirstlane_b32 s76, v114
    s_cmp_ge_u32 s77, 160000
    s_cbranch_scc1 l_rd12
    s_cmp_lt_u32 s76, 4
    s_cbranch_scc1 l_rv11
l_rd12:
    ds_read_b64 v[16:17], v9 offset:0
    ds_read_b64 v[18:19], v9 offset:8
    ds_read_b64 v[20:21], v9 offset:256
    ds_read_b64 v[22:23], v9 offset:264
    ds_read_b64 v[24:25], v9 offset:512
    ds_read_b64 v[26:27], v9 offset:520
    ds_read_b64 v[28:29], v9 offset:768
    ds_read_b64 v[30:31], v9 offset:776
    ds_read_b64 v[32:33], v9 offset:1024
    ds_read_b64 v[34:35], v9 offset:1032
    ds_read_b64 v[36:37], v9 offset:1280
    ds_read_b64 v[38:39], v9 offset:1288
    ds_read_b64 v[40:41], v9 offset:1536
    ds_read_b64 v[42:43], v9 offset:1544
    ds_read_b64 v[44:45], v9 offset:1792
    ds_read_b64 v[46:47], v9 offset:1800
    ds_read_b64 v[48:49], v9 offset:2048
    ds_read_b64 v[50:51], v9 offset:2056
    ds_read_b64 v[52:53], v9 offset:2304
    ds_read_b64 v[54:55], v9 offset:2312
    ds_read_b64 v[56:57], v9 offset:2560
    ds_read_b64 v[58:59], v9 offset:2568
    ds_read_b64 v[60:61], v9 offset:2816
    ds_read_b64 v[62:63], v9 offset:2824
    ds_read_b64 v[64:65], v9 offset:3072
    ds_read_b64 v[66:67], v9 offset:3080
    ds_read_b64 v[68:69], v9 offset:3328
    ds_read_b64 v[70:71], v9 offset:3336
    ds_read_b64 v[72:73], v9 offset:3584
    ds_read_b64 v[74:75], v9 offset:3592
    ds_read_b64 v[76:77], v9 offset:3840
    ds_read_b64 v[78:79], v9 offset:3848
    s_cmp_eq_u32 s3, 0
    s_cbranch_scc0 l_w113
    v_mov_b32 v112, 0
    v_mov_b32 v113, 0
    v_mov_b32 v114, 0
    v_mov_b32 v115, 0
    v_and_b32 v116, 31, v2
    v_lshlrev_b32 v116, 4, v116
    v_lshrrev_b32 v117, 5, v2
    v_mul_u32_u24 v117, 4608, v117
    v_add_u32 v116, v116, v117
    v_add_u32 v116, 153728, v116
    ds_write_b128 v116, v[112:115]
    s_lshl_b32 s75, s66, 5
    s_lshl_b32 s76, s75, 7
    s_add_u32 s76, s76, 6356992
    v_lshlrev_b32 v122, 7, v2
    s_mov_b32 s77, 0
    s_mov_b32 exec_hi, 0
l_wg14:
    buffer_load_ubyte v120, v2, s[8:11], s75 offen sc1
    s_mov_b64 s[40:41], 0
    s_cmp_eq_u32 s70, 0
    s_cbranch_scc0 l_wc16
    buffer_load_dword v121, v122, s[4:7], s76 offen sc1
    s_waitcnt vmcnt(0)
    v_subrev_u32 v121, s69, v121
    v_subrev_u32 v121, 1, v121
    v_cmp_gt_u32 s[40:41], 3, v121
l_wc16:
    s_waitcnt vmcnt(0)
    v_cmp_le_u32 vcc, 16, v120
    s_nop 1
    s_or_b64 vcc, vcc, s[40:41]
    s_cmp_eq_u64 vcc, exec
    s_cbranch_scc1 l_wd17
    s_add_u32 s77, s77, 1
    s_cmp_lt_u32 s77, 20000
    s_cbranch_scc1 l_wg14
l_wd17:
    s_mov_b64 exec, -1
l_w113:
    s_waitcnt lgkmcnt(0)
    s_barrier
    s_lshl_b32 s75, s63, 11
    s_add_u32 m0, s52, s75
    s_nop 0
    buffer_load_dwordx4 v3, s[4:7], s50 offen sc1 lds
    buffer_load_dwordx4 v3, s[4:7], s50 offen offset:1024 sc1 lds
    s_mov_b32 s75, 2097152
    buffer_load_dwordx2 v[124:125], v11, s[4:7], s75 offen offset:0 sc1
    buffer_load_dwordx2 v[126:127], v11, s[4:7], s75 offen offset:512 sc1
    buffer_load_dwordx2 v[128:129], v11, s[4:7], s75 offen offset:1024 sc1
    buffer_load_dwordx2 v[130:131], v11, s[4:7], s75 offen offset:1536 sc1
    s_lshl_b32 s49, s66, 5
    v_and_b32 v154, 31, v2
    s_waitcnt vmcnt(4) lgkmcnt(0)
    s_barrier
    ds_read_b128 a[0:3], v8 offset:3840
    ds_read_b128 a[4:7], v8 offset:3584
    ds_read_b128 a[8:11], v8 offset:3328
    ds_read_b128 a[12:15], v8 offset:3072
    ds_read_b128 a[16:19], v8 offset:2816
    ds_read_b128 a[20:23], v8 offset:2560
    ds_read_b128 a[24:27], v8 offset:2304
    ds_read_b128 a[28:31], v8 offset:2048
    ds_read_b128 a[32:35], v8 offset:1792
    ds_read_b128 a[36:39], v8 offset:1536
    ds_read_b128 a[40:43], v8 offset:1280
    ds_read_b128 a[44:47], v8 offset:1024
    ds_read_b128 a[48:51], v8 offset:768
    ds_read_b128 a[52:55], v8 offset:512
    ds_read_b128 a[56:59], v8 offset:256
    ds_read_b128 a[60:63], v8 offset:0
    s_add_u32 s75, s51, 12288
    s_cmp_eq_u32 s63, 0
    s_cselect_b32 s76, 49152, s51
    s_cselect_b32 s75, s75, 49152
    v_add_u32 v14, s76, v3
    v_add_u32 v15, s75, v3
    s_waitcnt lgkmcnt(15)
    v_mfma_f32_16x16x32_bf16 v[108:111], v[76:79], a[0:3], 0
    buffer_load_dwordx4 a[64:67], v13, s[4:7], s58 offen offset:0 sc1
    v_mfma_f32_16x16x32_bf16 v[104:107], v[68:71], a[0:3], 0
    buffer_load_dwordx4 a[68:71], v13, s[4:7], s59 offen offset:0 sc1
    v_mfma_f32_16x16x32_bf16 v[100:103], v[60:63], a[0:3], 0
    buffer_load_dwordx4 a[72:75], v13, s[4:7], s58 offen offset:1024 sc1
    v_mfma_f32_16x16x32_bf16 v[96:99], v[52:55], a[0:3], 0
    buffer_load_dwordx4 a[76:79], v13, s[4:7], s59 offen offset:1024 sc1
    v_mfma_f32_16x16x32_bf16 v[92:95], v[44:47], a[0:3], 0
    buffer_load_dwordx4 a[80:83], v13, s[4:7], s58 offen offset:2048 sc1
    v_mfma_f32_16x16x32_bf16 v[88:91], v[36:39], a[0:3], 0
    buffer_load_dwordx4 a[84:87], v13, s[4:7], s59 offen offset:2048 sc1
    v_mfma_f32_16x16x32_bf16 v[84:87], v[28:31], a[0:3], 0
    buffer_load_dwordx4 a[88:91], v13, s[4:7], s58 offen offset:3072 sc1
    v_mfma_f32_16x16x32_bf16 v[80:83], v[20:23], a[0:3], 0
    buffer_load_dwordx4 a[92:95], v13, s[4:7], s59 offen offset:3072 sc1
    s_waitcnt lgkmcnt(14)
    v_mfma_f32_16x16x32_bf16 v[108:111], v[72:75], a[4:7], v[108:111]
    buffer_load_ubyte v155, v154, s[8:11], s49 offen sc1
    v_mfma_f32_16x16x32_bf16 v[104:107], v[64:67], a[4:7], v[104:107]
    v_mfma_f32_16x16x32_bf16 v[100:103], v[56:59], a[4:7], v[100:103]
    v_mfma_f32_16x16x32_bf16 v[96:99], v[48:51], a[4:7], v[96:99]
    v_mfma_f32_16x16x32_bf16 v[92:95], v[40:43], a[4:7], v[92:95]
    v_mfma_f32_16x16x32_bf16 v[88:91], v[32:35], a[4:7], v[88:91]
    v_mfma_f32_16x16x32_bf16 v[84:87], v[24:27], a[4:7], v[84:87]
    v_mfma_f32_16x16x32_bf16 v[80:83], v[16:19], a[4:7], v[80:83]
    s_waitcnt lgkmcnt(0)
    v_mfma_f32_16x16x32_bf16 v[108:111], v[68:71], a[8:11], v[108:111]
    s_waitcnt vmcnt(9)
    v_lshlrev_b32 v112, 16, v124
    v_mfma_f32_16x16x32_bf16 v[104:107], v[60:63], a[8:11], v[104:107]
    v_and_b32 v113, s72, v124
    v_lshlrev_b32 v114, 16, v125
    v_mfma_f32_16x16x32_bf16 v[100:103], v[52:55], a[8:11], v[100:103]
    v_and_b32 v115, s72, v125
    v_lshlrev_b32 v116, 16, v126
    v_mfma_f32_16x16x32_bf16 v[96:99], v[44:47], a[8:11], v[96:99]
    v_and_b32 v117, s72, v126
    v_lshlrev_b32 v118, 16, v127
    v_mfma_f32_16x16x32_bf16 v[92:95], v[36:39], a[8:11], v[92:95]
    v_and_b32 v119, s72, v127
    v_lshlrev_b32 v140, 16, v128
    v_mfma_f32_16x16x32_bf16 v[88:91], v[28:31], a[8:11], v[88:91]
    v_and_b32 v141, s72, v128
    v_lshlrev_b32 v142, 16, v129
    v_mfma_f32_16x16x32_bf16 v[84:87], v[20:23], a[8:11], v[84:87]
    v_and_b32 v143, s72, v129
    v_lshlrev_b32 v144, 16, v130
    v_mfma_f32_16x16x32_bf16 v[108:111], v[64:67], a[12:15], v[108:111]
    ds_write_b128 v14, v[80:83] offset:0
    v_and_b32 v145, s72, v130
    v_lshlrev_b32 v146, 16, v131
    v_mfma_f32_16x16x32_bf16 v[104:107], v[56:59], a[12:15], v[104:107]
    v_and_b32 v147, s72, v131
    ds_read_b64 v[124:125], v12 offset:1536
    v_mfma_f32_16x16x32_bf16 v[100:103], v[48:51], a[12:15], v[100:103]
    ds_read_b64 v[126:127], v12 offset:1024
    ds_read_b64 v[128:129], v12 offset:512
    v_mfma_f32_16x16x32_bf16 v[96:99], v[40:43], a[12:15], v[96:99]
    ds_read_b64 v[130:131], v12 offset:0
    s_nop 0
    v_mfma_f32_16x16x32_bf16 v[92:95], v[32:35], a[12:15], v[92:95]
    s_nop 0
    s_nop 0
    v_mfma_f32_16x16x32_bf16 v[88:91], v[24:27], a[12:15], v[88:91]
    s_waitcnt lgkmcnt(0)
    v_lshlrev_b32 v123, 16, v124
    v_mfma_f32_16x16x32_bf16 v[84:87], v[16:19], a[12:15], v[84:87]
    v_and_b32 v122, s72, v124
    v_lshlrev_b32 v121, 16, v125
    v_mfma_f32_16x16x32_bf16 v[108:111], v[60:63], a[16:19], v[108:111]
    v_and_b32 v120, s72, v125
    v_lshlrev_b32 v135, 16, v126
    v_mfma_f32_16x16x32_bf16 v[104:107], v[52:55], a[16:19], v[104:107]
    v_and_b32 v134, s72, v126
    v_lshlrev_b32 v133, 16, v127
    v_mfma_f32_16x16x32_bf16 v[100:103], v[44:47], a[16:19], v[100:103]
    v_and_b32 v132, s72, v127
    v_lshlrev_b32 v139, 16, v128
    v_mfma_f32_16x16x32_bf16 v[96:99], v[36:39], a[16:19], v[96:99]
    v_and_b32 v138, s72, v128
    v_lshlrev_b32 v137, 16, v129
    v_mfma_f32_16x16x32_bf16 v[92:95], v[28:31], a[16:19], v[92:95]
    v_and_b32 v136, s72, v129
    v_lshlrev_b32 v151, 16, v130
    v_mfma_f32_16x16x32_bf16 v[88:91], v[20:23], a[16:19], v[88:91]
    v_and_b32 v150, s72, v130
    v_lshlrev_b32 v149, 16, v131
    v_mfma_f32_16x16x32_bf16 v[108:111], v[56:59], a[20:23], v[108:111]
    ds_write_b128 v14, v[84:87] offset:1024
    v_and_b32 v148, s72, v131
    v_mul_f32 v120, s71, v120
    v_mfma_f32_16x16x32_bf16 v[104:107], v[48:51], a[20:23], v[104:107]
    v_mul_f32 v121, s71, v121
    v_mul_f32 v122, s71, v122
    v_mfma_f32_16x16x32_bf16 v[100:103], v[40:43], a[20:23], v[100:103]
    v_mul_f32 v123, s71, v123
    v_mul_f32 v132, s71, v132
    v_mfma_f32_16x16x32_bf16 v[96:99], v[32:35], a[20:23], v[96:99]
    v_mul_f32 v133, s71, v133
    v_mul_f32 v134, s71, v134
    v_mfma_f32_16x16x32_bf16 v[92:95], v[24:27], a[20:23], v[92:95]
    v_mul_f32 v135, s71, v135
    v_mul_f32 v136, s71, v136
    v_mfma_f32_16x16x32_bf16 v[88:91], v[16:19], a[20:23], v[88:91]
    v_mul_f32 v137, s71, v137
    v_mul_f32 v138, s71, v138
    v_mfma_f32_16x16x32_bf16 v[108:111], v[52:55], a[24:27], v[108:111]
    v_mul_f32 v139, s71, v139
    v_mul_f32 v148, s71, v148
    v_mfma_f32_16x16x32_bf16 v[104:107], v[44:47], a[24:27], v[104:107]
    v_mul_f32 v149, s71, v149
    v_mul_f32 v150, s71, v150
    v_mfma_f32_16x16x32_bf16 v[100:103], v[36:39], a[24:27], v[100:103]
    v_mul_f32 v151, s71, v151
    v_mfma_f32_16x16x32_bf16 v[96:99], v[28:31], a[24:27], v[96:99]
    v_mfma_f32_16x16x32_bf16 v[92:95], v[20:23], a[24:27], v[92:95]
    v_mfma_f32_16x16x32_bf16 v[108:111], v[48:51], a[28:31], v[108:111]
    ds_write_b128 v14, v[88:91] offset:2048
    v_mfma_f32_16x16x32_bf16 v[104:107], v[40:43], a[28:31], v[104:107]
    v_mfma_f32_16x16x32_bf16 v[100:103], v[32:35], a[28:31], v[100:103]
    v_mfma_f32_16x16x32_bf16 v[96:99], v[24:27], a[28:31], v[96:99]
    v_mfma_f32_16x16x32_bf16 v[92:95], v[16:19], a[28:31], v[92:95]
    v_mfma_f32_16x16x32_bf16 v[108:111], v[44:47], a[32:35], v[108:111]
    s_waitcnt vmcnt(0)
    v_accvgpr_read_b32 v48, a64
    v_accvgpr_read_b32 v49, a65
    v_accvgpr_read_b32 v50, a66
    v_mfma_f32_16x16x32_bf16 v[104:107], v[36:39], a[32:35], v[104:107]
    v_accvgpr_read_b32 v51, a67
    v_accvgpr_read_b32 v52, a68
    v_accvgpr_read_b32 v53, a69
    v_accvgpr_read_b32 v54, a70
    v_mfma_f32_16x16x32_bf16 v[100:103], v[28:31], a[32:35], v[100:103]
    v_accvgpr_read_b32 v55, a71
    v_accvgpr_read_b32 v56, a72
    v_accvgpr_read_b32 v57, a73
    v_accvgpr_read_b32 v58, a74
    v_mfma_f32_16x16x32_bf16 v[96:99], v[20:23], a[32:35], v[96:99]
    v_accvgpr_read_b32 v59, a75
    v_accvgpr_read_b32 v60, a76
    v_accvgpr_read_b32 v61, a77
    v_accvgpr_read_b32 v62, a78
    v_mfma_f32_16x16x32_bf16 v[108:111], v[40:43], a[36:39], v[108:111]
    ds_write_b128 v14, v[92:95] offset:3072
    v_accvgpr_read_b32 v63, a79
    v_accvgpr_read_b32 v64, a80
    v_accvgpr_read_b32 v65, a81
    v_accvgpr_read_b32 v66, a82
    v_mfma_f32_16x16x32_bf16 v[104:107], v[32:35], a[36:39], v[104:107]
    v_accvgpr_read_b32 v67, a83
    v_accvgpr_read_b32 v68, a84
    v_accvgpr_read_b32 v69, a85
    v_accvgpr_read_b32 v70, a86
    v_mfma_f32_16x16x32_bf16 v[100:103], v[24:27], a[36:39], v[100:103]
    v_accvgpr_read_b32 v71, a87
    v_accvgpr_read_b32 v72, a88
    v_accvgpr_read_b32 v73, a89
    v_accvgpr_read_b32 v74, a90
    v_mfma_f32_16x16x32_bf16 v[96:99], v[16:19], a[36:39], v[96:99]
    v_accvgpr_read_b32 v75, a91
    v_accvgpr_read_b32 v76, a92
    v_accvgpr_read_b32 v77, a93
    v_accvgpr_read_b32 v78, a94
    v_mfma_f32_16x16x32_bf16 v[108:111], v[36:39], a[40:43], v[108:111]
    v_accvgpr_read_b32 v79, a95
    v_xor_b32 v48, s32, v48
    v_xor_b32 v49, s33, v49
    v_xor_b32 v50, s34, v50
    v_mfma_f32_16x16x32_bf16 v[104:107], v[28:31], a[40:43], v[104:107]
    v_xor_b32 v51, s35, v51
    v_xor_b32 v52, s32, v52
    v_xor_b32 v53, s33, v53
    v_xor_b32 v54, s34, v54
    v_mfma_f32_16x16x32_bf16 v[100:103], v[20:23], a[40:43], v[100:103]
    v_xor_b32 v55, s35, v55
    v_xor_b32 v56, s32, v56
    v_xor_b32 v57, s33, v57
    v_xor_b32 v58, s34, v58
    v_mfma_f32_16x16x32_bf16 v[108:111], v[32:35], a[44:47], v[108:111]
    ds_write_b128 v15, v[96:99] offset:0
    v_xor_b32 v59, s35, v59
    v_xor_b32 v60, s32, v60
    v_xor_b32 v61, s33, v61
    v_xor_b32 v62, s34, v62
    v_mfma_f32_16x16x32_bf16 v[104:107], v[24:27], a[44:47], v[104:107]
    v_xor_b32 v63, s35, v63
    v_xor_b32 v64, s32, v64
    v_xor_b32 v65, s33, v65
    v_xor_b32 v66, s34, v66
    v_mfma_f32_16x16x32_bf16 v[100:103], v[16:19], a[44:47], v[100:103]
    v_xor_b32 v67, s35, v67
    v_xor_b32 v68, s32, v68
    v_xor_b32 v69, s33, v69
    v_xor_b32 v70, s34, v70
    v_mfma_f32_16x16x32_bf16 v[108:111], v[28:31], a[48:51], v[108:111]
    v_xor_b32 v71, s35, v71
    v_xor_b32 v72, s32, v72
    v_xor_b32 v73, s33, v73
    v_xor_b32 v74, s34, v74
    v_mfma_f32_16x16x32_bf16 v[104:107], v[20:23], a[48:51], v[104:107]
    v_xor_b32 v75, s35, v75
    v_xor_b32 v76, s32, v76
    v_xor_b32 v77, s33, v77
    v_xor_b32 v78, s34, v78
    v_mfma_f32_16x16x32_bf16 v[108:111], v[24:27], a[52:55], v[108:111]
    ds_write_b128 v15, v[100:103] offset:1024
    v_xor_b32 v79, s35, v79
    v_or_b32 v156, v48, v49
    v_or_b32 v157, v50, v51
    v_or3_b32 v156, v156, v52, v53
    v_mfma_f32_16x16x32_bf16 v[104:107], v[16:19], a[52:55], v[104:107]
    v_or3_b32 v157, v157, v54, v55
    v_or3_b32 v156, v156, v56, v57
    v_or3_b32 v157, v157, v58, v59
    v_or3_b32 v156, v156, v60, v61
    v_mfma_f32_16x16x32_bf16 v[108:111], v[20:23], a[56:59], v[108:111]
    v_or3_b32 v157, v157, v62, v63
    v_or3_b32 v156, v156, v64, v65
    v_or3_b32 v157, v157, v66, v67
    v_or3_b32 v156, v156, v68, v69
    v_mfma_f32_16x16x32_bf16 v[108:111], v[16:19], a[60:63], v[108:111]
    ds_write_b128 v15, v[104:107] offset:2048
    v_or3_b32 v157, v157, v70, v71
    v_or3_b32 v156, v156, v72, v73
    v_or3_b32 v157, v157, v74, v75
    v_or3_b32 v156, v156, v76, v77
    v_or3_b32 v157, v157, v78, v79
    v_or_b32 v156, v156, v157
    v_and_b32 v156, 0xff, v156
    s_mul_i32 s75, s63, 12288
    s_add_u32 s75, s75, s51
    v_add_u32 v9, s75, v3
    v_and_b32 v10, 1, v7
    v_lshlrev_b32 v10, 9, v10
    v_lshl_add_u32 v10, v6, 5, v10
    v_lshrrev_b32 v11, 1, v7
    v_lshl_add_u32 v10, v11, 4, v10
    s_add_u32 s50, s50, 4194304
    ds_write_b128 v15, v[108:111] offset:3072
    s_cmp_eq_u32 s63, 0
    s_cbranch_scc0 l_xo18
    v_add_f32 v80, v80, v120
    v_add_f32 v81, v81, v121
    v_add_f32 v82, v82, v122
    v_add_f32 v83, v83, v123
    v_add_f32 v84, v84, v132
    v_add_f32 v85, v85, v133
    v_add_f32 v86, v86, v134
    v_add_f32 v87, v87, v135
    v_add_f32 v88, v88, v136
    v_add_f32 v89, v89, v137
    v_add_f32 v90, v90, v138
    v_add_f32 v91, v91, v139
    v_add_f32 v92, v92, v148
    v_add_f32 v93, v93, v149
    v_add_f32 v94, v94, v150
    v_add_f32 v95, v95, v151
    s_waitcnt lgkmcnt(0)
    s_barrier
    ds_read_b128 v[16:19], v9 offset:0
    ds_read_b128 v[20:23], v9 offset:1024
    ds_read_b128 v[24:27], v9 offset:2048
    ds_read_b128 v[28:31], v9 offset:3072
    ds_read_b128 v[32:35], v9 offset:4096
    ds_read_b128 v[36:39], v9 offset:5120
    ds_read_b128 v[40:43], v9 offset:6144
    ds_read_b128 v[44:47], v9 offset:7168
    ds_read_b128 v[96:99], v9 offset:8192
    ds_read_b128 v[100:103], v9 offset:9216
    ds_read_b128 v[104:107], v9 offset:10240
    ds_read_b128 v[108:111], v9 offset:11264
    s_mov_b32 s77, 0
l_tc20:
    v_cmp_ne_u32 vcc, 0, v156
    s_add_u32 s77, s77, 1
    s_cmp_eq_u64 vcc, 0
    s_cbranch_scc1 l_tk21
    s_cmp_ge_u32 s77, 20000
    s_cbranch_scc1 l_tk21
    buffer_load_dwordx4 v[48:51], v13, s[4:7], s58 offen offset:0 sc1
    buffer_load_dwordx4 v[52:55], v13, s[4:7], s59 offen offset:0 sc1
    buffer_load_dwordx4 v[56:59], v13, s[4:7], s58 offen offset:1024 sc1
    buffer_load_dwordx4 v[60:63], v13, s[4:7], s59 offen offset:1024 sc1
    buffer_load_dwordx4 v[64:67], v13, s[4:7], s58 offen offset:2048 sc1
    buffer_load_dwordx4 v[68:71], v13, s[4:7], s59 offen offset:2048 sc1
    buffer_load_dwordx4 v[72:75], v13, s[4:7], s58 offen offset:3072 sc1
    buffer_load_dwordx4 v[76:79], v13, s[4:7], s59 offen offset:3072 sc1
    s_waitcnt vmcnt(0)
    v_xor_b32 v48, s32, v48
    v_xor_b32 v49, s33, v49
    v_xor_b32 v50, s34, v50
    v_xor_b32 v51, s35, v51
    v_xor_b32 v52, s32, v52
    v_xor_b32 v53, s33, v53
    v_xor_b32 v54, s34, v54
    v_xor_b32 v55, s35, v55
    v_xor_b32 v56, s32, v56
    v_xor_b32 v57, s33, v57
    v_xor_b32 v58, s34, v58
    v_xor_b32 v59, s35, v59
    v_xor_b32 v60, s32, v60
    v_xor_b32 v61, s33, v61
    v_xor_b32 v62, s34, v62
    v_xor_b32 v63, s35, v63
    v_xor_b32 v64, s32, v64
    v_xor_b32 v65, s33, v65
    v_xor_b32 v66, s34, v66
    v_xor_b32 v67, s35, v67
    v_xor_b32 v68, s32, v68
    v_xor_b32 v69, s33, v69
    v_xor_b32 v70, s34, v70
    v_xor_b32 v71, s35, v71
    v_xor_b32 v72, s32, v72
    v_xor_b32 v73, s33, v73
    v_xor_b32 v74, s34, v74
    v_xor_b32 v75, s35, v75
    v_xor_b32 v76, s32, v76
    v_xor_b32 v77, s33, v77
    v_xor_b32 v78, s34, v78
    v_xor_b32 v79, s35, v79
    v_or_b32 v156, v48, v49
    v_or_b32 v157, v50, v51
    v_or3_b32 v156, v156, v52, v53
    v_or3_b32 v157, v157, v54, v55
    v_or3_b32 v156, v156, v56, v57
    v_or3_b32 v157, v157, v58, v59
    v_or3_b32 v156, v156, v60, v61
    v_or3_b32 v157, v157, v62, v63
    v_or3_b32 v156, v156, v64, v65
    v_or3_b32 v157, v157, v66, v67
    v_or3_b32 v156, v156, v68, v69
    v_or3_b32 v157, v157, v70, v71
    v_or3_b32 v156, v156, v72, v73
    v_or3_b32 v157, v157, v74, v75
    v_or3_b32 v156, v156, v76, v77
    v_or3_b32 v157, v157, v78, v79
    v_or_b32 v156, v156, v157
    v_and_b32 v156, 0xff, v156
    s_branch l_tc20
l_tk21:
    v_fma_f32 v48, v112, v48, v49
    v_fma_f32 v50, v113, v50, v51
    v_fma_f32 v52, v114, v52, v53
    v_fma_f32 v54, v115, v54, v55
    v_fma_f32 v56, v116, v56, v57
    v_fma_f32 v58, v117, v58, v59
    v_fma_f32 v60, v118, v60, v61
    v_fma_f32 v62, v119, v62, v63
    v_fma_f32 v64, v140, v64, v65
    v_fma_f32 v66, v141, v66, v67
    v_fma_f32 v68, v142, v68, v69
    v_fma_f32 v70, v143, v70, v71
    v_fma_f32 v72, v144, v72, v73
    v_fma_f32 v74, v145, v74, v75
    v_fma_f32 v76, v146, v76, v77
    v_fma_f32 v78, v147, v78, v79
    s_waitcnt lgkmcnt(8)
    v_pk_add_f32 v[80:81], v[80:81], v[16:17]
    v_pk_add_f32 v[82:83], v[82:83], v[18:19]
    v_pk_add_f32 v[84:85], v[84:85], v[20:21]
    v_pk_add_f32 v[86:87], v[86:87], v[22:23]
    v_pk_add_f32 v[88:89], v[88:89], v[24:25]
    v_pk_add_f32 v[90:91], v[90:91], v[26:27]
    v_pk_add_f32 v[92:93], v[92:93], v[28:29]
    v_pk_add_f32 v[94:95], v[94:95], v[30:31]
    s_waitcnt lgkmcnt(4)
    v_pk_add_f32 v[80:81], v[80:81], v[32:33]
    v_pk_add_f32 v[82:83], v[82:83], v[34:35]
    v_pk_add_f32 v[84:85], v[84:85], v[36:37]
    v_pk_add_f32 v[86:87], v[86:87], v[38:39]
    v_pk_add_f32 v[88:89], v[88:89], v[40:41]
    v_pk_add_f32 v[90:91], v[90:91], v[42:43]
    v_pk_add_f32 v[92:93], v[92:93], v[44:45]
    v_pk_add_f32 v[94:95], v[94:95], v[46:47]
    s_waitcnt lgkmcnt(0)
    v_pk_add_f32 v[80:81], v[80:81], v[96:97]
    v_pk_add_f32 v[82:83], v[82:83], v[98:99]
    v_pk_add_f32 v[84:85], v[84:85], v[100:101]
    v_pk_add_f32 v[86:87], v[86:87], v[102:103]
    v_pk_add_f32 v[88:89], v[88:89], v[104:105]
    v_pk_add_f32 v[90:91], v[90:91], v[106:107]
    v_pk_add_f32 v[92:93], v[92:93], v[108:109]
    v_pk_add_f32 v[94:95], v[94:95], v[110:111]
    v_fmac_f32 v112, v48, v80
    v_fmac_f32 v113, v50, v81
    v_fmac_f32 v114, v52, v82
    v_fmac_f32 v115, v54, v83
    v_fmac_f32 v116, v56, v84
    v_fmac_f32 v117, v58, v85
    v_fmac_f32 v118, v60, v86
    v_fmac_f32 v119, v62, v87
    v_cvt_pk_bf16_f32 v124, v112, v113
    v_cvt_pk_bf16_f32 v125, v114, v115
    v_cvt_pk_bf16_f32 v126, v116, v117
    v_cvt_pk_bf16_f32 v127, v118, v119
    s_nop 0
    v_permlane16_swap_b32 v124, v126
    v_permlane16_swap_b32 v125, v127
    buffer_store_dwordx4 v[124:127], v10, s[4:7], s50 offen offset:0 sc1
    v_fmac_f32 v140, v64, v88
    v_fmac_f32 v141, v66, v89
    v_fmac_f32 v142, v68, v90
    v_fmac_f32 v143, v70, v91
    v_fmac_f32 v144, v72, v92
    v_fmac_f32 v145, v74, v93
    v_fmac_f32 v146, v76, v94
    v_fmac_f32 v147, v78, v95
    v_cvt_pk_bf16_f32 v128, v140, v141
    v_cvt_pk_bf16_f32 v129, v142, v143
    v_cvt_pk_bf16_f32 v130, v144, v145
    v_cvt_pk_bf16_f32 v131, v146, v147
    s_nop 0
    v_permlane16_swap_b32 v128, v130
    v_permlane16_swap_b32 v129, v131
    buffer_store_dwordx4 v[128:131], v10, s[4:7], s50 offen offset:1024 sc1
    s_branch l_xd19
l_xo18:
    v_add_f32 v96, v96, v120
    v_add_f32 v97, v97, v121
    v_add_f32 v98, v98, v122
    v_add_f32 v99, v99, v123
    v_add_f32 v100, v100, v132
    v_add_f32 v101, v101, v133
    v_add_f32 v102, v102, v134
    v_add_f32 v103, v103, v135
    v_add_f32 v104, v104, v136
    v_add_f32 v105, v105, v137
    v_add_f32 v106, v106, v138
    v_add_f32 v107, v107, v139
    v_add_f32 v108, v108, v148
    v_add_f32 v109, v109, v149
    v_add_f32 v110, v110, v150
    v_add_f32 v111, v111, v151
    s_waitcnt lgkmcnt(0)
    s_barrier
    ds_read_b128 v[16:19], v9 offset:0
    ds_read_b128 v[20:23], v9 offset:1024
    ds_read_b128 v[24:27], v9 offset:2048
    ds_read_b128 v[28:31], v9 offset:3072
    ds_read_b128 v[32:35], v9 offset:4096
    ds_read_b128 v[36:39], v9 offset:5120
    ds_read_b128 v[40:43], v9 offset:6144
    ds_read_b128 v[44:47], v9 offset:7168
    ds_read_b128 v[80:83], v9 offset:8192
    ds_read_b128 v[84:87], v9 offset:9216
    ds_read_b128 v[88:91], v9 offset:10240
    ds_read_b128 v[92:95], v9 offset:11264
    s_mov_b32 s77, 0
l_tc22:
    v_cmp_ne_u32 vcc, 0, v156
    s_add_u32 s77, s77, 1
    s_cmp_eq_u64 vcc, 0
    s_cbranch_scc1 l_tk23
    s_cmp_ge_u32 s77, 20000
    s_cbranch_scc1 l_tk23
    buffer_load_dwordx4 v[48:51], v13, s[4:7], s58 offen offset:0 sc1
    buffer_load_dwordx4 v[52:55], v13, s[4:7], s59 offen offset:0 sc1
    buffer_load_dwordx4 v[56:59], v13, s[4:7], s58 offen offset:1024 sc1
    buffer_load_dwordx4 v[60:63], v13, s[4:7], s59 offen offset:1024 sc1
    buffer_load_dwordx4 v[64:67], v13, s[4:7], s58 offen offset:2048 sc1
    buffer_load_dwordx4 v[68:71], v13, s[4:7], s59 offen offset:2048 sc1
    buffer_load_dwordx4 v[72:75], v13, s[4:7], s58 offen offset:3072 sc1
    buffer_load_dwordx4 v[76:79], v13, s[4:7], s59 offen offset:3072 sc1
    s_waitcnt vmcnt(0)
    v_xor_b32 v48, s32, v48
    v_xor_b32 v49, s33, v49
    v_xor_b32 v50, s34, v50
    v_xor_b32 v51, s35, v51
    v_xor_b32 v52, s32, v52
    v_xor_b32 v53, s33, v53
    v_xor_b32 v54, s34, v54
    v_xor_b32 v55, s35, v55
    v_xor_b32 v56, s32, v56
    v_xor_b32 v57, s33, v57
    v_xor_b32 v58, s34, v58
    v_xor_b32 v59, s35, v59
    v_xor_b32 v60, s32, v60
    v_xor_b32 v61, s33, v61
    v_xor_b32 v62, s34, v62
    v_xor_b32 v63, s35, v63
    v_xor_b32 v64, s32, v64
    v_xor_b32 v65, s33, v65
    v_xor_b32 v66, s34, v66
    v_xor_b32 v67, s35, v67
    v_xor_b32 v68, s32, v68
    v_xor_b32 v69, s33, v69
    v_xor_b32 v70, s34, v70
    v_xor_b32 v71, s35, v71
    v_xor_b32 v72, s32, v72
    v_xor_b32 v73, s33, v73
    v_xor_b32 v74, s34, v74
    v_xor_b32 v75, s35, v75
    v_xor_b32 v76, s32, v76
    v_xor_b32 v77, s33, v77
    v_xor_b32 v78, s34, v78
    v_xor_b32 v79, s35, v79
    v_or_b32 v156, v48, v49
    v_or_b32 v157, v50, v51
    v_or3_b32 v156, v156, v52, v53
    v_or3_b32 v157, v157, v54, v55
    v_or3_b32 v156, v156, v56, v57
    v_or3_b32 v157, v157, v58, v59
    v_or3_b32 v156, v156, v60, v61
    v_or3_b32 v157, v157, v62, v63
    v_or3_b32 v156, v156, v64, v65
    v_or3_b32 v157, v157, v66, v67
    v_or3_b32 v156, v156, v68, v69
    v_or3_b32 v157, v157, v70, v71
    v_or3_b32 v156, v156, v72, v73
    v_or3_b32 v157, v157, v74, v75
    v_or3_b32 v156, v156, v76, v77
    v_or3_b32 v157, v157, v78, v79
    v_or_b32 v156, v156, v157
    v_and_b32 v156, 0xff, v156
    s_branch l_tc22
l_tk23:
    v_fma_f32 v48, v112, v48, v49
    v_fma_f32 v50, v113, v50, v51
    v_fma_f32 v52, v114, v52, v53
    v_fma_f32 v54, v115, v54, v55
    v_fma_f32 v56, v116, v56, v57
    v_fma_f32 v58, v117, v58, v59
    v_fma_f32 v60, v118, v60, v61
    v_fma_f32 v62, v119, v62, v63
    v_fma_f32 v64, v140, v64, v65
    v_fma_f32 v66, v141, v66, v67
    v_fma_f32 v68, v142, v68, v69
    v_fma_f32 v70, v143, v70, v71
    v_fma_f32 v72, v144, v72, v73
    v_fma_f32 v74, v145, v74, v75
    v_fma_f32 v76, v146, v76, v77
    v_fma_f32 v78, v147, v78, v79
    s_waitcnt lgkmcnt(8)
    v_pk_add_f32 v[96:97], v[96:97], v[16:17]
    v_pk_add_f32 v[98:99], v[98:99], v[18:19]
    v_pk_add_f32 v[100:101], v[100:101], v[20:21]
    v_pk_add_f32 v[102:103], v[102:103], v[22:23]
    v_pk_add_f32 v[104:105], v[104:105], v[24:25]
    v_pk_add_f32 v[106:107], v[106:107], v[26:27]
    v_pk_add_f32 v[108:109], v[108:109], v[28:29]
    v_pk_add_f32 v[110:111], v[110:111], v[30:31]
    s_waitcnt lgkmcnt(4)
    v_pk_add_f32 v[96:97], v[96:97], v[32:33]
    v_pk_add_f32 v[98:99], v[98:99], v[34:35]
    v_pk_add_f32 v[100:101], v[100:101], v[36:37]
    v_pk_add_f32 v[102:103], v[102:103], v[38:39]
    v_pk_add_f32 v[104:105], v[104:105], v[40:41]
    v_pk_add_f32 v[106:107], v[106:107], v[42:43]
    v_pk_add_f32 v[108:109], v[108:109], v[44:45]
    v_pk_add_f32 v[110:111], v[110:111], v[46:47]
    s_waitcnt lgkmcnt(0)
    v_pk_add_f32 v[96:97], v[96:97], v[80:81]
    v_pk_add_f32 v[98:99], v[98:99], v[82:83]
    v_pk_add_f32 v[100:101], v[100:101], v[84:85]
    v_pk_add_f32 v[102:103], v[102:103], v[86:87]
    v_pk_add_f32 v[104:105], v[104:105], v[88:89]
    v_pk_add_f32 v[106:107], v[106:107], v[90:91]
    v_pk_add_f32 v[108:109], v[108:109], v[92:93]
    v_pk_add_f32 v[110:111], v[110:111], v[94:95]
    v_fmac_f32 v112, v48, v96
    v_fmac_f32 v113, v50, v97
    v_fmac_f32 v114, v52, v98
    v_fmac_f32 v115, v54, v99
    v_fmac_f32 v116, v56, v100
    v_fmac_f32 v117, v58, v101
    v_fmac_f32 v118, v60, v102
    v_fmac_f32 v119, v62, v103
    v_cvt_pk_bf16_f32 v124, v112, v113
    v_cvt_pk_bf16_f32 v125, v114, v115
    v_cvt_pk_bf16_f32 v126, v116, v117
    v_cvt_pk_bf16_f32 v127, v118, v119
    s_nop 0
    v_permlane16_swap_b32 v124, v126
    v_permlane16_swap_b32 v125, v127
    buffer_store_dwordx4 v[124:127], v10, s[4:7], s50 offen offset:0 sc1
    v_fmac_f32 v140, v64, v104
    v_fmac_f32 v141, v66, v105
    v_fmac_f32 v142, v68, v106
    v_fmac_f32 v143, v70, v107
    v_fmac_f32 v144, v72, v108
    v_fmac_f32 v145, v74, v109
    v_fmac_f32 v146, v76, v110
    v_fmac_f32 v147, v78, v111
    v_cvt_pk_bf16_f32 v128, v140, v141
    v_cvt_pk_bf16_f32 v129, v142, v143
    v_cvt_pk_bf16_f32 v130, v144, v145
    v_cvt_pk_bf16_f32 v131, v146, v147
    s_nop 0
    v_permlane16_swap_b32 v128, v130
    v_permlane16_swap_b32 v129, v131
    buffer_store_dwordx4 v[128:131], v10, s[4:7], s50 offen offset:1024 sc1
l_xd19:
    v_and_b32 v155, 15, v155
    v_cmp_eq_u32 vcc, s68, v155
    s_nop 0
    s_cmp_eq_u32 vcc_lo, -1
    s_cselect_b32 s70, 1, 0
    s_barrier
    s_lshr_b32 s40, s66, 1
    s_lshl_b32 s40, s40, 2
    s_and_b32 s41, s67, 3
    s_add_u32 s40, s40, s41
    s_and_b32 s41, s66, 1
    s_lshl_b32 s41, s41, 3
    s_lshr_b32 s47, s67, 2
    s_add_u32 s41, s41, s47
    s_lshl_b32 s42, s40, 3
    s_mul_i32 s42, s42, 896
    s_add_u32 s42, s42, 6455296
    v_lshlrev_b32 v116, 2, v7
    v_xor_b32 v116, v116, v6
    v_lshlrev_b32 v116, 4, v116
    v_lshl_add_u32 v128, v7, 12, v116
    s_lshl_b32 s45, s3, 11
    s_add_u32 s45, s45, 114816
    s_lshl_b32 s46, s3, 15
    s_lshl_b32 s75, s41, 8
    s_add_u32 s46, s46, s75
    s_add_u32 s46, s46, 4194304
    v_lshrrev_b32 v4, 3, v2
    v_and_b32 v116, 7, v2
    v_lshrrev_b32 v117, 2, v2
    v_and_b32 v117, 4, v117
    v_xor_b32 v116, v116, v117
    v_lshlrev_b32 v116, 4, v116
    v_lshl_add_u32 v4, v4, 10, v116
    s_and_b32 s75, s67, 7
    s_lshl_b32 s75, s75, 7
    v_add_u32 v4, s75, v4
    v_and_b32 v116, 1, v7
    v_lshrrev_b32 v117, 1, v7
    v_lshrrev_b32 v118, 2, v6
    v_lshl_add_u32 v119, v117, 3, v118
    v_and_b32 v120, 1, v6
    v_bfe_u32 v121, v6, 1, 1
    v_lshl_add_u32 v122, v120, 1, v121
    v_mul_u32_u24 v135, 224, v119
    v_lshl_add_u32 v135, v122, 3, v135
    v_mul_u32_u24 v122, 57472, v116
    v_add_u32 v135, v135, v122
    v_lshl_add_u32 v122, v116, 1, v121
    v_lshlrev_b32 v118, 2, v118
    s_lshl_b32 s75, s73, 2
    v_add_u32 v136, s75, v122
    v_xor_b32 v136, v136, v118
    v_lshlrev_b32 v136, 4, v136
    v_lshl_add_u32 v136, v120, 3, v136
    v_lshl_add_u32 v136, v119, 8, v136
    v_add_u32 v136, 114816, v136
    v_lshlrev_b32 v137, 6, v117
    v_add_u32 v137, 155776, v137
    s_lshl_b32 s47, s47, 1
    s_waitcnt vmcnt(0)
    v_mov_b32 v116, 159248
    v_mov_b32 v117, 1
    s_mov_b64 exec, 1
    ds_add_u32 v116, v117
    s_mov_b64 exec, -1
    s_cmp_eq_u32 s3, 0
    s_cbranch_scc0 l_w224
    v_mov_b32 v116, 159248
    s_mov_b32 s77, 0
l_rv27:
    ds_read_b32 v118, v116
    s_add_u32 s77, s77, 1
    s_waitcnt lgkmcnt(0)
    v_readfirstlane_b32 s76, v118
    s_cmp_ge_u32 s77, 160000
    s_cbranch_scc1 l_rd28
    s_cmp_lt_u32 s76, 4
    s_cbranch_scc1 l_rv27
l_rd28:
    s_lshl_b32 s75, s66, 5
    s_add_u32 s75, s75, s67
    s_or_b32 s76, s68, 48
    v_mov_b32 v20, s76
    v_mov_b32 v21, 0
    s_mov_b64 exec, 1
    buffer_store_byte v20, v21, s[8:11], s75 offen
    s_cmp_eq_u32 s70, 0
    s_cbranch_scc0 l_sg29
    s_lshl_b32 s75, s75, 7
    s_add_u32 s75, s75, 6356992
    s_add_u32 s76, s69, 2
    v_mov_b32 v22, s76
    buffer_store_dword v22, v21, s[4:7], s75 offen sc1
l_sg29:
    s_mov_b64 exec, -1
    s_mov_b32 s24, s40
    s_mov_b32 s25, s41
    s_mov_b32 s26, s42
    s_mov_b32 s27, s43
    s_mov_b32 s28, s44
    s_mov_b32 s29, s45
    s_mov_b32 s30, s46
    s_mov_b32 s31, s47
    s_lshl_b32 s48, s66, 10
    s_add_u32 s48, s48, 6397952
    s_cmp_eq_u32 s67, 0
    s_cbranch_scc0 l_w2n25
    s_lshl_b32 s75, s66, 5
    s_lshl_b32 s76, s75, 7
    s_add_u32 s76, s76, 6356992
    v_lshlrev_b32 v22, 7, v2
    s_mov_b32 s77, 0
    s_mov_b32 exec_hi, 0
l_wg30:
    buffer_load_ubyte v20, v2, s[8:11], s75 offen sc1
    s_mov_b64 s[40:41], 0
    s_cmp_eq_u32 s70, 0
    s_cbranch_scc0 l_wc32
    buffer_load_dword v21, v22, s[4:7], s76 offen sc1
    s_waitcnt vmcnt(0)
    v_subrev_u32 v21, s69, v21
    v_subrev_u32 v21, 2, v21
    v_cmp_gt_u32 s[40:41], 2, v21
l_wc32:
    s_waitcnt vmcnt(0)
    v_cmp_le_u32 vcc, 32, v20
    s_nop 1
    s_or_b64 vcc, vcc, s[40:41]
    s_cmp_eq_u64 vcc, exec
    s_cbranch_scc1 l_wd33
    s_add_u32 s77, s77, 1
    s_cmp_lt_u32 s77, 20000
    s_cbranch_scc1 l_wg30
l_wd33:
    s_mov_b64 exec, -1
    s_lshl_b32 s75, s66, 7
    s_add_u32 s75, s75, 6397952
    s_add_u32 s76, s69, 2
    v_mov_b32 v20, s76
    v_lshlrev_b32 v21, 10, v2
    s_mov_b64 exec, 0xff
    buffer_store_dword v20, v21, s[4:7], s75 offen sc1
    s_mov_b64 exec, -1
l_w2n25:
    v_mov_b32 v116, 159256
    v_mov_b32 v117, 4
    ds_write_b32 v116, v117
    v_and_b32 v21, 7, v2
    v_lshlrev_b32 v21, 7, v21
    s_add_u32 s76, s69, 2
    s_mov_b32 s77, 0
l_vl34:
    buffer_load_dword v20, v21, s[4:7], s48 offen sc1
    s_waitcnt vmcnt(0)
    v_cmp_ne_u32 vcc, s76, v20
    s_nop 1
    s_cmp_eq_u64 vcc, 0
    s_cbranch_scc1 l_vd35
    s_add_u32 s77, s77, 1
    s_cmp_lt_u32 s77, 20000
    s_cbranch_scc1 l_vl34
l_vd35:
    s_mov_b32 s40, s24
    s_mov_b32 s41, s25
    s_mov_b32 s42, s26
    s_mov_b32 s43, s27
    s_mov_b32 s44, s28
    s_mov_b32 s45, s29
    s_mov_b32 s46, s30
    s_mov_b32 s47, s31
    s_branch l_w2j26
l_w224:
    v_mov_b32 v116, 159252
    s_mov_b32 s77, 0
l_rv36:
    ds_read_b32 v118, v116
    s_add_u32 s77, s77, 1
    s_waitcnt lgkmcnt(0)
    v_readfirstlane_b32 s76, v118
    s_cmp_ge_u32 s77, 160000
    s_cbranch_scc1 l_rd37
    s_cmp_lt_u32 s76, 4
    s_cbranch_scc1 l_rv36
l_rd37:
    s_sub_u32 s75, s3, 1
    s_lshl_b32 s76, s75, 5
    v_add_u32 v8, s76, v135
    ds_read_b64_tr_b16 v[80:81], v8 offset:0
    ds_read_b64_tr_b16 v[82:83], v8 offset:896
    ds_read_b64_tr_b16 v[84:85], v8 offset:3584
    ds_read_b64_tr_b16 v[86:87], v8 offset:4480
    ds_read_b64_tr_b16 v[88:89], v8 offset:7168
    ds_read_b64_tr_b16 v[90:91], v8 offset:8064
    ds_read_b64_tr_b16 v[92:93], v8 offset:10752
    ds_read_b64_tr_b16 v[94:95], v8 offset:11648
    v_mov_b32 v96, 0x3f803f80
    v_mov_b32 v97, 0x3f803f80
    v_mov_b32 v98, 0x3f803f80
    v_mov_b32 v99, 0x3f803f80
    s_mul_i32 s76, s47, 448
    s_lshl_b32 s75, s75, 7
    s_add_u32 s75, s75, s76
    s_add_u32 s75, s75, s42
    v_lshlrev_b32 v9, 1, v2
    s_waitcnt lgkmcnt(6)
    v_mfma_f32_32x32x16_bf16 v[16:31], v[80:83], v[96:99], 0
    s_waitcnt lgkmcnt(4)
    v_mfma_f32_32x32x16_bf16 v[16:31], v[84:87], v[96:99], v[16:31]
    s_waitcnt lgkmcnt(2)
    v_mfma_f32_32x32x16_bf16 v[16:31], v[88:91], v[96:99], v[16:31]
    s_waitcnt lgkmcnt(0)
    v_mfma_f32_32x32x16_bf16 v[16:31], v[92:95], v[96:99], v[16:31]
    s_mov_b32 exec_lo, 1
    s_mov_b32 exec_hi, 1
    s_nop 9
    buffer_store_dwordx4 v[16:19], v9, s[4:7], s75 offen offset:0 sc1
    buffer_store_dwordx4 v[20:23], v9, s[4:7], s75 offen offset:16 sc1
    buffer_store_dwordx4 v[24:27], v9, s[4:7], s75 offen offset:32 sc1
    buffer_store_dwordx4 v[28:31], v9, s[4:7], s75 offen offset:48 sc1
    s_mov_b64 exec, -1
l_w2j26:
    v_add_u32 v8, 0, v135
    v_mov_b32 v12, 0
    v_mov_b32 v13, 0
    v_mov_b32 v14, 0
    v_mov_b32 v15, 0
    s_barrier
    s_add_u32 s53, s47, 0
    s_and_b32 s53, s53, 15
    s_lshl_b32 s53, s53, 17
    s_add_u32 m0, s45, 0
    s_add_u32 s53, s53, s46
    buffer_load_dwordx4 v128, s[4:7], s53 offen sc1 lds
    s_add_u32 m0, s45, 1024
    s_add_u32 s53, s53, 16384
    buffer_load_dwordx4 v128, s[4:7], s53 offen sc1 lds
    s_add_u32 s53, s47, 1
    s_and_b32 s53, s53, 15
    s_lshl_b32 s53, s53, 17
    s_add_u32 m0, s45, 8192
    s_add_u32 s53, s53, s46
    buffer_load_dwordx4 v128, s[4:7], s53 offen sc1 lds
    s_add_u32 m0, s45, 9216
    s_add_u32 s53, s53, 16384
    buffer_load_dwordx4 v128, s[4:7], s53 offen sc1 lds
    s_add_u32 s53, s47, 2
    s_and_b32 s53, s53, 15
    s_lshl_b32 s53, s53, 17
    s_add_u32 m0, s45, 16384
    s_add_u32 s53, s53, s46
    buffer_load_dwordx4 v128, s[4:7], s53 offen sc1 lds
    s_add_u32 m0, s45, 17408
    s_add_u32 s53, s53, 16384
    buffer_load_dwordx4 v128, s[4:7], s53 offen sc1 lds
    s_add_u32 s53, s47, 3
    s_and_b32 s53, s53, 15
    s_lshl_b32 s53, s53, 17
    s_add_u32 m0, s45, 24576
    s_add_u32 s53, s53, s46
    buffer_load_dwordx4 v128, s[4:7], s53 offen sc1 lds
    s_add_u32 m0, s45, 25600
    s_add_u32 s53, s53, 16384
    buffer_load_dwordx4 v128, s[4:7], s53 offen sc1 lds
    s_add_u32 s53, s47, 4
    s_and_b32 s53, s53, 15
    s_lshl_b32 s53, s53, 17
    s_add_u32 m0, s45, 32768
    s_add_u32 s53, s53, s46
    buffer_load_dwordx4 v128, s[4:7], s53 offen sc1 lds
    s_add_u32 m0, s45, 33792
    s_add_u32 s53, s53, 16384
    buffer_load_dwordx4 v128, s[4:7], s53 offen sc1 lds
    v_mov_b32 v116, 159260
    v_mov_b32 v117, 1
    s_mov_b64 exec, 1
    ds_add_u32 v116, v117
    s_mov_b64 exec, -1
    s_waitcnt vmcnt(8) lgkmcnt(0)
    s_barrier
    ds_read_b64_tr_b16 v[112:113], v136 offset:0
    ds_read_b64_tr_b16 v[114:115], v136 offset:1024
    ds_read_b64_tr_b16 v[80:81], v8 offset:0
    ds_read_b64_tr_b16 v[82:83], v8 offset:896
    ds_read_b64_tr_b16 v[84:85], v8 offset:32
    ds_read_b64_tr_b16 v[86:87], v8 offset:928
    ds_read_b64_tr_b16 v[88:89], v8 offset:64
    ds_read_b64_tr_b16 v[90:91], v8 offset:960
    ds_read_b64_tr_b16 v[92:93], v8 offset:96
    ds_read_b64_tr_b16 v[94:95], v8 offset:992
    s_waitcnt lgkmcnt(8)
    s_waitcnt lgkmcnt(6)
    v_mfma_f32_32x32x16_bf16 v[16:31], v[80:83], v[112:115], 0
    ds_read_b64_tr_b16 v[116:117], v136 offset:4096
    ds_read_b64_tr_b16 v[118:119], v136 offset:5120
    ds_read_b64_tr_b16 v[96:97], v8 offset:3584
    ds_read_b64_tr_b16 v[98:99], v8 offset:4480
    ds_read_b64_tr_b16 v[100:101], v8 offset:3616
    v_lshlrev_b32 v138, 16, v112
    v_and_b32 v139, s72, v112
    v_add_f32 v12, v12, v138
    s_waitcnt lgkmcnt(9)
    v_mfma_f32_32x32x16_bf16 v[32:47], v[84:87], v[112:115], 0
    ds_read_b64_tr_b16 v[102:103], v8 offset:4512
    ds_read_b64_tr_b16 v[104:105], v8 offset:3648
    ds_read_b64_tr_b16 v[106:107], v8 offset:4544
    ds_read_b64_tr_b16 v[108:109], v8 offset:3680
    ds_read_b64_tr_b16 v[110:111], v8 offset:4576
    v_add_f32 v13, v13, v139
    v_fmac_f32 v14, v138, v138
    v_fmac_f32 v15, v139, v139
    s_waitcnt lgkmcnt(12)
    v_mfma_f32_32x32x16_bf16 v[48:63], v[88:91], v[112:115], 0
    v_lshlrev_b32 v140, 16, v113
    v_and_b32 v141, s72, v113
    v_add_f32 v12, v12, v140
    s_waitcnt lgkmcnt(10)
    v_mfma_f32_32x32x16_bf16 v[64:79], v[92:95], v[112:115], 0
    v_add_f32 v13, v13, v141
    v_fmac_f32 v14, v140, v140
    v_fmac_f32 v15, v141, v141
    s_waitcnt vmcnt(6) lgkmcnt(0)
    s_barrier
    s_cmp_eq_u32 s3, 0
    s_cbranch_scc0 l_cf38
    s_lshl_b32 s75, s66, 5
    s_add_u32 s75, s75, s67
    s_lshl_b32 s75, s75, 7
    s_add_u32 s75, s75, 6422528
    v_mov_b32 v142, s69
    v_mov_b32 v143, 0
    s_mov_b64 exec, 1
    buffer_store_dword v142, v143, s[4:7], s75 offen sc1
    s_mov_b64 exec, -1
l_cf38:
    v_mfma_f32_32x32x16_bf16 v[16:31], v[96:99], v[116:119], v[16:31]
    ds_read_b64_tr_b16 v[112:113], v136 offset:8192
    ds_read_b64_tr_b16 v[114:115], v136 offset:9216
    ds_read_b64_tr_b16 v[80:81], v8 offset:7168
    v_lshlrev_b32 v138, 16, v116
    v_and_b32 v139, s72, v116
    v_add_f32 v12, v12, v138
    v_mfma_f32_32x32x16_bf16 v[32:47], v[100:103], v[116:119], v[32:47]
    ds_read_b64_tr_b16 v[82:83], v8 offset:8064
    ds_read_b64_tr_b16 v[84:85], v8 offset:7200
    ds_read_b64_tr_b16 v[86:87], v8 offset:8096
    v_add_f32 v13, v13, v139
    v_fmac_f32 v14, v138, v138
    v_fmac_f32 v15, v139, v139
    s_add_u32 s53, s47, 5
    s_and_b32 s53, s53, 15
    s_lshl_b32 s53, s53, 17
    s_add_u32 m0, s45, 0
    s_add_u32 s53, s53, s46
    buffer_load_dwordx4 v128, s[4:7], s53 offen sc1 lds
    v_mfma_f32_32x32x16_bf16 v[48:63], v[104:107], v[116:119], v[48:63]
    ds_read_b64_tr_b16 v[88:89], v8 offset:7232
    ds_read_b64_tr_b16 v[90:91], v8 offset:8128
    ds_read_b64_tr_b16 v[92:93], v8 offset:7264
    v_lshlrev_b32 v140, 16, v117
    v_and_b32 v141, s72, v117
    v_add_f32 v12, v12, v140
    v_mfma_f32_32x32x16_bf16 v[64:79], v[108:111], v[116:119], v[64:79]
    ds_read_b64_tr_b16 v[94:95], v8 offset:8160
    v_add_f32 v13, v13, v141
    v_fmac_f32 v14, v140, v140
    v_fmac_f32 v15, v141, v141
    s_waitcnt lgkmcnt(8)
    s_waitcnt lgkmcnt(6)
    v_mfma_f32_32x32x16_bf16 v[16:31], v[80:83], v[112:115], v[16:31]
    ds_read_b64_tr_b16 v[116:117], v136 offset:12288
    ds_read_b64_tr_b16 v[118:119], v136 offset:13312
    ds_read_b64_tr_b16 v[96:97], v8 offset:10752
    ds_read_b64_tr_b16 v[98:99], v8 offset:11648
    ds_read_b64_tr_b16 v[100:101], v8 offset:10784
    v_lshlrev_b32 v138, 16, v112
    v_and_b32 v139, s72, v112
    v_add_f32 v12, v12, v138
    s_waitcnt lgkmcnt(9)
    v_mfma_f32_32x32x16_bf16 v[32:47], v[84:87], v[112:115], v[32:47]
    ds_read_b64_tr_b16 v[102:103], v8 offset:11680
    ds_read_b64_tr_b16 v[104:105], v8 offset:10816
    ds_read_b64_tr_b16 v[106:107], v8 offset:11712
    ds_read_b64_tr_b16 v[108:109], v8 offset:10848
    ds_read_b64_tr_b16 v[110:111], v8 offset:11744
    v_add_f32 v13, v13, v139
    v_fmac_f32 v14, v138, v138
    v_fmac_f32 v15, v139, v139
    s_add_u32 m0, s45, 1024
    s_add_u32 s53, s53, 16384
    buffer_load_dwordx4 v128, s[4:7], s53 offen sc1 lds
    s_waitcnt lgkmcnt(12)
    v_mfma_f32_32x32x16_bf16 v[48:63], v[88:91], v[112:115], v[48:63]
    v_lshlrev_b32 v140, 16, v113
    v_and_b32 v141, s72, v113
    v_add_f32 v12, v12, v140
    s_waitcnt lgkmcnt(10)
    v_mfma_f32_32x32x16_bf16 v[64:79], v[92:95], v[112:115], v[64:79]
    v_add_f32 v13, v13, v141
    v_fmac_f32 v14, v140, v140
    v_fmac_f32 v15, v141, v141
    s_waitcnt vmcnt(6) lgkmcnt(0)
    s_barrier
    v_mfma_f32_32x32x16_bf16 v[16:31], v[96:99], v[116:119], v[16:31]
    ds_read_b64_tr_b16 v[112:113], v136 offset:16384
    ds_read_b64_tr_b16 v[114:115], v136 offset:17408
    ds_read_b64_tr_b16 v[80:81], v8 offset:14336
    v_lshlrev_b32 v138, 16, v116
    v_and_b32 v139, s72, v116
    v_add_f32 v12, v12, v138
    v_mfma_f32_32x32x16_bf16 v[32:47], v[100:103], v[116:119], v[32:47]
    ds_read_b64_tr_b16 v[82:83], v8 offset:15232
    ds_read_b64_tr_b16 v[84:85], v8 offset:14368
    ds_read_b64_tr_b16 v[86:87], v8 offset:15264
    v_add_f32 v13, v13, v139
    v_fmac_f32 v14, v138, v138
    v_fmac_f32 v15, v139, v139
    s_add_u32 s53, s47, 6
    s_and_b32 s53, s53, 15
    s_lshl_b32 s53, s53, 17
    s_add_u32 m0, s45, 8192
    s_add_u32 s53, s53, s46
    buffer_load_dwordx4 v128, s[4:7], s53 offen sc1 lds
    v_mfma_f32_32x32x16_bf16 v[48:63], v[104:107], v[116:119], v[48:63]
    ds_read_b64_tr_b16 v[88:89], v8 offset:14400
    ds_read_b64_tr_b16 v[90:91], v8 offset:15296
    ds_read_b64_tr_b16 v[92:93], v8 offset:14432
    v_lshlrev_b32 v140, 16, v117
    v_and_b32 v141, s72, v117
    v_add_f32 v12, v12, v140
    v_mfma_f32_32x32x16_bf16 v[64:79], v[108:111], v[116:119], v[64:79]
    ds_read_b64_tr_b16 v[94:95], v8 offset:15328
    v_add_f32 v13, v13, v141
    v_fmac_f32 v14, v140, v140
    v_fmac_f32 v15, v141, v141
    s_waitcnt lgkmcnt(8)
    s_waitcnt lgkmcnt(6)
    v_mfma_f32_32x32x16_bf16 v[16:31], v[80:83], v[112:115], v[16:31]
    ds_read_b64_tr_b16 v[116:117], v136 offset:20480
    ds_read_b64_tr_b16 v[118:119], v136 offset:21504
    ds_read_b64_tr_b16 v[96:97], v8 offset:17920
    ds_read_b64_tr_b16 v[98:99], v8 offset:18816
    ds_read_b64_tr_b16 v[100:101], v8 offset:17952
    v_lshlrev_b32 v138, 16, v112
    v_and_b32 v139, s72, v112
    v_add_f32 v12, v12, v138
    s_waitcnt lgkmcnt(9)
    v_mfma_f32_32x32x16_bf16 v[32:47], v[84:87], v[112:115], v[32:47]
    ds_read_b64_tr_b16 v[102:103], v8 offset:18848
    ds_read_b64_tr_b16 v[104:105], v8 offset:17984
    ds_read_b64_tr_b16 v[106:107], v8 offset:18880
    ds_read_b64_tr_b16 v[108:109], v8 offset:18016
    ds_read_b64_tr_b16 v[110:111], v8 offset:18912
    v_add_f32 v13, v13, v139
    v_fmac_f32 v14, v138, v138
    v_fmac_f32 v15, v139, v139
    s_add_u32 m0, s45, 9216
    s_add_u32 s53, s53, 16384
    buffer_load_dwordx4 v128, s[4:7], s53 offen sc1 lds
    s_waitcnt lgkmcnt(12)
    v_mfma_f32_32x32x16_bf16 v[48:63], v[88:91], v[112:115], v[48:63]
    v_lshlrev_b32 v140, 16, v113
    v_and_b32 v141, s72, v113
    v_add_f32 v12, v12, v140
    s_waitcnt lgkmcnt(10)
    v_mfma_f32_32x32x16_bf16 v[64:79], v[92:95], v[112:115], v[64:79]
    v_add_f32 v13, v13, v141
    v_fmac_f32 v14, v140, v140
    v_fmac_f32 v15, v141, v141
    s_waitcnt vmcnt(6) lgkmcnt(0)
    s_barrier
    v_mfma_f32_32x32x16_bf16 v[16:31], v[96:99], v[116:119], v[16:31]
    ds_read_b64_tr_b16 v[112:113], v136 offset:24576
    ds_read_b64_tr_b16 v[114:115], v136 offset:25600
    ds_read_b64_tr_b16 v[80:81], v8 offset:21504
    v_lshlrev_b32 v138, 16, v116
    v_and_b32 v139, s72, v116
    v_add_f32 v12, v12, v138
    v_mfma_f32_32x32x16_bf16 v[32:47], v[100:103], v[116:119], v[32:47]
    ds_read_b64_tr_b16 v[82:83], v8 offset:22400
    ds_read_b64_tr_b16 v[84:85], v8 offset:21536
    ds_read_b64_tr_b16 v[86:87], v8 offset:22432
    v_add_f32 v13, v13, v139
    v_fmac_f32 v14, v138, v138
    v_fmac_f32 v15, v139, v139
    s_add_u32 s53, s47, 7
    s_and_b32 s53, s53, 15
    s_lshl_b32 s53, s53, 17
    s_add_u32 m0, s45, 16384
    s_add_u32 s53, s53, s46
    buffer_load_dwordx4 v128, s[4:7], s53 offen sc1 lds
    v_mfma_f32_32x32x16_bf16 v[48:63], v[104:107], v[116:119], v[48:63]
    ds_read_b64_tr_b16 v[88:89], v8 offset:21568
    ds_read_b64_tr_b16 v[90:91], v8 offset:22464
    ds_read_b64_tr_b16 v[92:93], v8 offset:21600
    v_lshlrev_b32 v140, 16, v117
    v_and_b32 v141, s72, v117
    v_add_f32 v12, v12, v140
    v_mfma_f32_32x32x16_bf16 v[64:79], v[108:111], v[116:119], v[64:79]
    ds_read_b64_tr_b16 v[94:95], v8 offset:22496
    v_add_f32 v13, v13, v141
    v_fmac_f32 v14, v140, v140
    v_fmac_f32 v15, v141, v141
    s_waitcnt lgkmcnt(8)
    s_waitcnt lgkmcnt(6)
    v_mfma_f32_32x32x16_bf16 v[16:31], v[80:83], v[112:115], v[16:31]
    ds_read_b64_tr_b16 v[116:117], v136 offset:28672
    ds_read_b64_tr_b16 v[118:119], v136 offset:29696
    ds_read_b64_tr_b16 v[96:97], v8 offset:25088
    ds_read_b64_tr_b16 v[98:99], v8 offset:25984
    ds_read_b64_tr_b16 v[100:101], v8 offset:25120
    v_lshlrev_b32 v138, 16, v112
    v_and_b32 v139, s72, v112
    v_add_f32 v12, v12, v138
    s_waitcnt lgkmcnt(9)
    v_mfma_f32_32x32x16_bf16 v[32:47], v[84:87], v[112:115], v[32:47]
    ds_read_b64_tr_b16 v[102:103], v8 offset:26016
    ds_read_b64_tr_b16 v[104:105], v8 offset:25152
    ds_read_b64_tr_b16 v[106:107], v8 offset:26048
    ds_read_b64_tr_b16 v[108:109], v8 offset:25184
    ds_read_b64_tr_b16 v[110:111], v8 offset:26080
    v_add_f32 v13, v13, v139
    v_fmac_f32 v14, v138, v138
    v_fmac_f32 v15, v139, v139
    s_add_u32 m0, s45, 17408
    s_add_u32 s53, s53, 16384
    buffer_load_dwordx4 v128, s[4:7], s53 offen sc1 lds
    s_waitcnt lgkmcnt(12)
    v_mfma_f32_32x32x16_bf16 v[48:63], v[88:91], v[112:115], v[48:63]
    v_lshlrev_b32 v140, 16, v113
    v_and_b32 v141, s72, v113
    v_add_f32 v12, v12, v140
    s_waitcnt lgkmcnt(10)
    v_mfma_f32_32x32x16_bf16 v[64:79], v[92:95], v[112:115], v[64:79]
    v_add_f32 v13, v13, v141
    v_fmac_f32 v14, v140, v140
    v_fmac_f32 v15, v141, v141
    s_waitcnt vmcnt(6) lgkmcnt(0)
    s_barrier
    v_mfma_f32_32x32x16_bf16 v[16:31], v[96:99], v[116:119], v[16:31]
    ds_read_b64_tr_b16 v[112:113], v136 offset:32768
    ds_read_b64_tr_b16 v[114:115], v136 offset:33792
    ds_read_b64_tr_b16 v[80:81], v8 offset:28672
    v_lshlrev_b32 v138, 16, v116
    v_and_b32 v139, s72, v116
    v_add_f32 v12, v12, v138
    v_mfma_f32_32x32x16_bf16 v[32:47], v[100:103], v[116:119], v[32:47]
    ds_read_b64_tr_b16 v[82:83], v8 offset:29568
    ds_read_b64_tr_b16 v[84:85], v8 offset:28704
    ds_read_b64_tr_b16 v[86:87], v8 offset:29600
    v_add_f32 v13, v13, v139
    v_fmac_f32 v14, v138, v138
    v_fmac_f32 v15, v139, v139
    s_add_u32 s53, s47, 8
    s_and_b32 s53, s53, 15
    s_lshl_b32 s53, s53, 17
    s_add_u32 m0, s45, 24576
    s_add_u32 s53, s53, s46
    buffer_load_dwordx4 v128, s[4:7], s53 offen sc1 lds
    v_mfma_f32_32x32x16_bf16 v[48:63], v[104:107], v[116:119], v[48:63]
    ds_read_b64_tr_b16 v[88:89], v8 offset:28736
    ds_read_b64_tr_b16 v[90:91], v8 offset:29632
    ds_read_b64_tr_b16 v[92:93], v8 offset:28768
    v_lshlrev_b32 v140, 16, v117
    v_and_b32 v141, s72, v117
    v_add_f32 v12, v12, v140
    v_mfma_f32_32x32x16_bf16 v[64:79], v[108:111], v[116:119], v[64:79]
    ds_read_b64_tr_b16 v[94:95], v8 offset:29664
    v_add_f32 v13, v13, v141
    v_fmac_f32 v14, v140, v140
    v_fmac_f32 v15, v141, v141
    s_waitcnt lgkmcnt(8)
    s_waitcnt lgkmcnt(6)
    v_mfma_f32_32x32x16_bf16 v[16:31], v[80:83], v[112:115], v[16:31]
    ds_read_b64_tr_b16 v[116:117], v136 offset:36864
    ds_read_b64_tr_b16 v[118:119], v136 offset:37888
    ds_read_b64_tr_b16 v[96:97], v8 offset:32256
    ds_read_b64_tr_b16 v[98:99], v8 offset:33152
    ds_read_b64_tr_b16 v[100:101], v8 offset:32288
    v_lshlrev_b32 v138, 16, v112
    v_and_b32 v139, s72, v112
    v_add_f32 v12, v12, v138
    s_waitcnt lgkmcnt(9)
    v_mfma_f32_32x32x16_bf16 v[32:47], v[84:87], v[112:115], v[32:47]
    ds_read_b64_tr_b16 v[102:103], v8 offset:33184
    ds_read_b64_tr_b16 v[104:105], v8 offset:32320
    ds_read_b64_tr_b16 v[106:107], v8 offset:33216
    ds_read_b64_tr_b16 v[108:109], v8 offset:32352
    ds_read_b64_tr_b16 v[110:111], v8 offset:33248
    v_add_f32 v13, v13, v139
    v_fmac_f32 v14, v138, v138
    v_fmac_f32 v15, v139, v139
    s_add_u32 m0, s45, 25600
    s_add_u32 s53, s53, 16384
    buffer_load_dwordx4 v128, s[4:7], s53 offen sc1 lds
    s_waitcnt lgkmcnt(12)
    v_mfma_f32_32x32x16_bf16 v[48:63], v[88:91], v[112:115], v[48:63]
    v_lshlrev_b32 v140, 16, v113
    v_and_b32 v141, s72, v113
    v_add_f32 v12, v12, v140
    s_waitcnt lgkmcnt(10)
    v_mfma_f32_32x32x16_bf16 v[64:79], v[92:95], v[112:115], v[64:79]
    v_add_f32 v13, v13, v141
    v_fmac_f32 v14, v140, v140
    v_fmac_f32 v15, v141, v141
    s_waitcnt vmcnt(6) lgkmcnt(0)
    s_barrier
    v_mfma_f32_32x32x16_bf16 v[16:31], v[96:99], v[116:119], v[16:31]
    ds_read_b64_tr_b16 v[112:113], v136 offset:0
    ds_read_b64_tr_b16 v[114:115], v136 offset:1024
    ds_read_b64_tr_b16 v[80:81], v8 offset:35840
    v_lshlrev_b32 v138, 16, v116
    v_and_b32 v139, s72, v116
    v_add_f32 v12, v12, v138
    v_mfma_f32_32x32x16_bf16 v[32:47], v[100:103], v[116:119], v[32:47]
    ds_read_b64_tr_b16 v[82:83], v8 offset:36736
    ds_read_b64_tr_b16 v[84:85], v8 offset:35872
    ds_read_b64_tr_b16 v[86:87], v8 offset:36768
    v_add_f32 v13, v13, v139
    v_fmac_f32 v14, v138, v138
    v_fmac_f32 v15, v139, v139
    s_add_u32 s53, s47, 9
    s_and_b32 s53, s53, 15
    s_lshl_b32 s53, s53, 17
    s_add_u32 m0, s45, 32768
    s_add_u32 s53, s53, s46
    buffer_load_dwordx4 v128, s[4:7], s53 offen sc1 lds
    v_mfma_f32_32x32x16_bf16 v[48:63], v[104:107], v[116:119], v[48:63]
    ds_read_b64_tr_b16 v[88:89], v8 offset:35904
    ds_read_b64_tr_b16 v[90:91], v8 offset:36800
    ds_read_b64_tr_b16 v[92:93], v8 offset:35936
    v_lshlrev_b32 v140, 16, v117
    v_and_b32 v141, s72, v117
    v_add_f32 v12, v12, v140
    v_mfma_f32_32x32x16_bf16 v[64:79], v[108:111], v[116:119], v[64:79]
    ds_read_b64_tr_b16 v[94:95], v8 offset:36832
    v_add_f32 v13, v13, v141
    v_fmac_f32 v14, v140, v140
    v_fmac_f32 v15, v141, v141
    s_waitcnt lgkmcnt(8)
    s_waitcnt lgkmcnt(6)
    v_mfma_f32_32x32x16_bf16 v[16:31], v[80:83], v[112:115], v[16:31]
    ds_read_b64_tr_b16 v[116:117], v136 offset:4096
    ds_read_b64_tr_b16 v[118:119], v136 offset:5120
    ds_read_b64_tr_b16 v[96:97], v8 offset:39424
    ds_read_b64_tr_b16 v[98:99], v8 offset:40320
    ds_read_b64_tr_b16 v[100:101], v8 offset:39456
    v_lshlrev_b32 v138, 16, v112
    v_and_b32 v139, s72, v112
    v_add_f32 v12, v12, v138
    s_waitcnt lgkmcnt(9)
    v_mfma_f32_32x32x16_bf16 v[32:47], v[84:87], v[112:115], v[32:47]
    ds_read_b64_tr_b16 v[102:103], v8 offset:40352
    ds_read_b64_tr_b16 v[104:105], v8 offset:39488
    ds_read_b64_tr_b16 v[106:107], v8 offset:40384
    ds_read_b64_tr_b16 v[108:109], v8 offset:39520
    ds_read_b64_tr_b16 v[110:111], v8 offset:40416
    v_add_f32 v13, v13, v139
    v_fmac_f32 v14, v138, v138
    v_fmac_f32 v15, v139, v139
    s_add_u32 m0, s45, 33792
    s_add_u32 s53, s53, 16384
    buffer_load_dwordx4 v128, s[4:7], s53 offen sc1 lds
    s_waitcnt lgkmcnt(12)
    v_mfma_f32_32x32x16_bf16 v[48:63], v[88:91], v[112:115], v[48:63]
    v_lshlrev_b32 v140, 16, v113
    v_and_b32 v141, s72, v113
    v_add_f32 v12, v12, v140
    s_waitcnt lgkmcnt(10)
    v_mfma_f32_32x32x16_bf16 v[64:79], v[92:95], v[112:115], v[64:79]
    v_add_f32 v13, v13, v141
    v_fmac_f32 v14, v140, v140
    v_fmac_f32 v15, v141, v141
    s_waitcnt vmcnt(6) lgkmcnt(0)
    s_barrier
    v_mfma_f32_32x32x16_bf16 v[16:31], v[96:99], v[116:119], v[16:31]
    ds_read_b64_tr_b16 v[112:113], v136 offset:8192
    ds_read_b64_tr_b16 v[114:115], v136 offset:9216
    ds_read_b64_tr_b16 v[80:81], v8 offset:43008
    v_lshlrev_b32 v138, 16, v116
    v_and_b32 v139, s72, v116
    v_add_f32 v12, v12, v138
    v_mfma_f32_32x32x16_bf16 v[32:47], v[100:103], v[116:119], v[32:47]
    ds_read_b64_tr_b16 v[82:83], v8 offset:43904
    ds_read_b64_tr_b16 v[84:85], v8 offset:43040
    ds_read_b64_tr_b16 v[86:87], v8 offset:43936
    v_add_f32 v13, v13, v139
    v_fmac_f32 v14, v138, v138
    v_fmac_f32 v15, v139, v139
    s_add_u32 s53, s47, 10
    s_and_b32 s53, s53, 15
    s_lshl_b32 s53, s53, 17
    s_add_u32 m0, s45, 0
    s_add_u32 s53, s53, s46
    buffer_load_dwordx4 v128, s[4:7], s53 offen sc1 lds
    v_mfma_f32_32x32x16_bf16 v[48:63], v[104:107], v[116:119], v[48:63]
    ds_read_b64_tr_b16 v[88:89], v8 offset:43072
    ds_read_b64_tr_b16 v[90:91], v8 offset:43968
    ds_read_b64_tr_b16 v[92:93], v8 offset:43104
    v_lshlrev_b32 v140, 16, v117
    v_and_b32 v141, s72, v117
    v_add_f32 v12, v12, v140
    v_mfma_f32_32x32x16_bf16 v[64:79], v[108:111], v[116:119], v[64:79]
    ds_read_b64_tr_b16 v[94:95], v8 offset:44000
    v_add_f32 v13, v13, v141
    v_fmac_f32 v14, v140, v140
    v_fmac_f32 v15, v141, v141
    s_waitcnt lgkmcnt(8)
    s_waitcnt lgkmcnt(6)
    v_mfma_f32_32x32x16_bf16 v[16:31], v[80:83], v[112:115], v[16:31]
    ds_read_b64_tr_b16 v[116:117], v136 offset:12288
    ds_read_b64_tr_b16 v[118:119], v136 offset:13312
    ds_read_b64_tr_b16 v[96:97], v8 offset:46592
    ds_read_b64_tr_b16 v[98:99], v8 offset:47488
    ds_read_b64_tr_b16 v[100:101], v8 offset:46624
    v_lshlrev_b32 v138, 16, v112
    v_and_b32 v139, s72, v112
    v_add_f32 v12, v12, v138
    s_waitcnt lgkmcnt(9)
    v_mfma_f32_32x32x16_bf16 v[32:47], v[84:87], v[112:115], v[32:47]
    ds_read_b64_tr_b16 v[102:103], v8 offset:47520
    ds_read_b64_tr_b16 v[104:105], v8 offset:46656
    ds_read_b64_tr_b16 v[106:107], v8 offset:47552
    ds_read_b64_tr_b16 v[108:109], v8 offset:46688
    ds_read_b64_tr_b16 v[110:111], v8 offset:47584
    v_add_f32 v13, v13, v139
    v_fmac_f32 v14, v138, v138
    v_fmac_f32 v15, v139, v139
    s_add_u32 m0, s45, 1024
    s_add_u32 s53, s53, 16384
    buffer_load_dwordx4 v128, s[4:7], s53 offen sc1 lds
    s_waitcnt lgkmcnt(12)
    v_mfma_f32_32x32x16_bf16 v[48:63], v[88:91], v[112:115], v[48:63]
    v_lshlrev_b32 v140, 16, v113
    v_and_b32 v141, s72, v113
    v_add_f32 v12, v12, v140
    s_waitcnt lgkmcnt(10)
    v_mfma_f32_32x32x16_bf16 v[64:79], v[92:95], v[112:115], v[64:79]
    v_add_f32 v13, v13, v141
    v_fmac_f32 v14, v140, v140
    v_fmac_f32 v15, v141, v141
    s_waitcnt vmcnt(6) lgkmcnt(0)
    s_barrier
    v_mfma_f32_32x32x16_bf16 v[16:31], v[96:99], v[116:119], v[16:31]
    ds_read_b64_tr_b16 v[112:113], v136 offset:16384
    ds_read_b64_tr_b16 v[114:115], v136 offset:17408
    ds_read_b64_tr_b16 v[80:81], v8 offset:50176
    v_lshlrev_b32 v138, 16, v116
    v_and_b32 v139, s72, v116
    v_add_f32 v12, v12, v138
    v_mfma_f32_32x32x16_bf16 v[32:47], v[100:103], v[116:119], v[32:47]
    ds_read_b64_tr_b16 v[82:83], v8 offset:51072
    ds_read_b64_tr_b16 v[84:85], v8 offset:50208
    ds_read_b64_tr_b16 v[86:87], v8 offset:51104
    v_add_f32 v13, v13, v139
    v_fmac_f32 v14, v138, v138
    v_fmac_f32 v15, v139, v139
    s_add_u32 s53, s47, 11
    s_and_b32 s53, s53, 15
    s_lshl_b32 s53, s53, 17
    s_add_u32 m0, s45, 8192
    s_add_u32 s53, s53, s46
    buffer_load_dwordx4 v128, s[4:7], s53 offen sc1 lds
    v_mfma_f32_32x32x16_bf16 v[48:63], v[104:107], v[116:119], v[48:63]
    ds_read_b64_tr_b16 v[88:89], v8 offset:50240
    ds_read_b64_tr_b16 v[90:91], v8 offset:51136
    ds_read_b64_tr_b16 v[92:93], v8 offset:50272
    v_lshlrev_b32 v140, 16, v117
    v_and_b32 v141, s72, v117
    v_add_f32 v12, v12, v140
    v_mfma_f32_32x32x16_bf16 v[64:79], v[108:111], v[116:119], v[64:79]
    ds_read_b64_tr_b16 v[94:95], v8 offset:51168
    v_add_f32 v13, v13, v141
    v_fmac_f32 v14, v140, v140
    v_fmac_f32 v15, v141, v141
    s_waitcnt lgkmcnt(8)
    s_waitcnt lgkmcnt(6)
    v_mfma_f32_32x32x16_bf16 v[16:31], v[80:83], v[112:115], v[16:31]
    ds_read_b64_tr_b16 v[116:117], v136 offset:20480
    ds_read_b64_tr_b16 v[118:119], v136 offset:21504
    ds_read_b64_tr_b16 v[96:97], v8 offset:53760
    ds_read_b64_tr_b16 v[98:99], v8 offset:54656
    ds_read_b64_tr_b16 v[100:101], v8 offset:53792
    v_lshlrev_b32 v138, 16, v112
    v_and_b32 v139, s72, v112
    v_add_f32 v12, v12, v138
    s_waitcnt lgkmcnt(9)
    v_mfma_f32_32x32x16_bf16 v[32:47], v[84:87], v[112:115], v[32:47]
    ds_read_b64_tr_b16 v[102:103], v8 offset:54688
    ds_read_b64_tr_b16 v[104:105], v8 offset:53824
    ds_read_b64_tr_b16 v[106:107], v8 offset:54720
    ds_read_b64_tr_b16 v[108:109], v8 offset:53856
    ds_read_b64_tr_b16 v[110:111], v8 offset:54752
    v_add_f32 v13, v13, v139
    v_fmac_f32 v14, v138, v138
    v_fmac_f32 v15, v139, v139
    s_add_u32 m0, s45, 9216
    s_add_u32 s53, s53, 16384
    buffer_load_dwordx4 v128, s[4:7], s53 offen sc1 lds
    s_waitcnt lgkmcnt(12)
    v_mfma_f32_32x32x16_bf16 v[48:63], v[88:91], v[112:115], v[48:63]
    v_lshlrev_b32 v140, 16, v113
    v_and_b32 v141, s72, v113
    v_add_f32 v12, v12, v140
    s_waitcnt lgkmcnt(10)
    v_mfma_f32_32x32x16_bf16 v[64:79], v[92:95], v[112:115], v[64:79]
    v_add_f32 v13, v13, v141
    v_fmac_f32 v14, v140, v140
    v_fmac_f32 v15, v141, v141
    s_waitcnt vmcnt(6) lgkmcnt(0)
    s_barrier
    s_lshl_b32 s43, s66, 5
    s_and_b32 s75, s67, 3
    s_add_u32 s43, s43, s75
    s_lshl_b32 s43, s43, 7
    s_add_u32 s43, s43, 6422528
    v_and_b32 v150, 7, v2
    v_lshlrev_b32 v150, 9, v150
    buffer_load_dword v151, v150, s[4:7], s43 offen sc1
    v_mfma_f32_32x32x16_bf16 v[16:31], v[96:99], v[116:119], v[16:31]
    ds_read_b64_tr_b16 v[112:113], v136 offset:24576
    ds_read_b64_tr_b16 v[114:115], v136 offset:25600
    ds_read_b64_tr_b16 v[80:81], v8 offset:0
    v_lshlrev_b32 v138, 16, v116
    v_and_b32 v139, s72, v116
    v_add_f32 v12, v12, v138
    v_mfma_f32_32x32x16_bf16 v[32:47], v[100:103], v[116:119], v[32:47]
    ds_read_b64_tr_b16 v[82:83], v8 offset:896
    ds_read_b64_tr_b16 v[84:85], v8 offset:32
    ds_read_b64_tr_b16 v[86:87], v8 offset:928
    v_add_f32 v13, v13, v139
    v_fmac_f32 v14, v138, v138
    v_fmac_f32 v15, v139, v139
    s_add_u32 s53, s47, 12
    s_and_b32 s53, s53, 15
    s_lshl_b32 s53, s53, 17
    s_add_u32 m0, s45, 16384
    s_add_u32 s53, s53, s46
    buffer_load_dwordx4 v128, s[4:7], s53 offen sc1 lds
    v_mfma_f32_32x32x16_bf16 v[48:63], v[104:107], v[116:119], v[48:63]
    ds_read_b64_tr_b16 v[88:89], v8 offset:64
    ds_read_b64_tr_b16 v[90:91], v8 offset:960
    ds_read_b64_tr_b16 v[92:93], v8 offset:96
    v_lshlrev_b32 v140, 16, v117
    v_and_b32 v141, s72, v117
    v_add_f32 v12, v12, v140
    v_mfma_f32_32x32x16_bf16 v[64:79], v[108:111], v[116:119], v[64:79]
    ds_read_b64_tr_b16 v[94:95], v8 offset:992
    v_add_f32 v13, v13, v141
    v_fmac_f32 v14, v140, v140
    v_fmac_f32 v15, v141, v141
    s_waitcnt lgkmcnt(8)
    s_waitcnt lgkmcnt(6)
    v_mfma_f32_32x32x16_bf16 v[16:31], v[80:83], v[112:115], v[16:31]
    ds_read_b64_tr_b16 v[116:117], v136 offset:28672
    ds_read_b64_tr_b16 v[118:119], v136 offset:29696
    ds_read_b64_tr_b16 v[96:97], v8 offset:3584
    ds_read_b64_tr_b16 v[98:99], v8 offset:4480
    ds_read_b64_tr_b16 v[100:101], v8 offset:3616
    v_lshlrev_b32 v138, 16, v112
    v_and_b32 v139, s72, v112
    v_add_f32 v12, v12, v138
    s_waitcnt lgkmcnt(9)
    v_mfma_f32_32x32x16_bf16 v[32:47], v[84:87], v[112:115], v[32:47]
    ds_read_b64_tr_b16 v[102:103], v8 offset:4512
    ds_read_b64_tr_b16 v[104:105], v8 offset:3648
    ds_read_b64_tr_b16 v[106:107], v8 offset:4544
    ds_read_b64_tr_b16 v[108:109], v8 offset:3680
    ds_read_b64_tr_b16 v[110:111], v8 offset:4576
    v_add_f32 v13, v13, v139
    v_fmac_f32 v14, v138, v138
    v_fmac_f32 v15, v139, v139
    s_add_u32 m0, s45, 17408
    s_add_u32 s53, s53, 16384
    buffer_load_dwordx4 v128, s[4:7], s53 offen sc1 lds
    s_waitcnt lgkmcnt(12)
    v_mfma_f32_32x32x16_bf16 v[48:63], v[88:91], v[112:115], v[48:63]
    v_lshlrev_b32 v140, 16, v113
    v_and_b32 v141, s72, v113
    v_add_f32 v12, v12, v140
    s_waitcnt lgkmcnt(10)
    v_mfma_f32_32x32x16_bf16 v[64:79], v[92:95], v[112:115], v[64:79]
    v_add_f32 v13, v13, v141
    v_fmac_f32 v14, v140, v140
    v_fmac_f32 v15, v141, v141
    s_waitcnt vmcnt(7) lgkmcnt(0)
    s_barrier
    v_mfma_f32_32x32x16_bf16 v[16:31], v[96:99], v[116:119], v[16:31]
    ds_read_b64_tr_b16 v[112:113], v136 offset:32768
    ds_read_b64_tr_b16 v[114:115], v136 offset:33792
    ds_read_b64_tr_b16 v[80:81], v8 offset:7168
    v_lshlrev_b32 v138, 16, v116
    v_and_b32 v139, s72, v116
    v_add_f32 v12, v12, v138
    v_mfma_f32_32x32x16_bf16 v[32:47], v[100:103], v[116:119], v[32:47]
    ds_read_b64_tr_b16 v[82:83], v8 offset:8064
    ds_read_b64_tr_b16 v[84:85], v8 offset:7200
    ds_read_b64_tr_b16 v[86:87], v8 offset:8096
    v_add_f32 v13, v13, v139
    v_fmac_f32 v14, v138, v138
    v_fmac_f32 v15, v139, v139
    s_add_u32 s53, s47, 13
    s_and_b32 s53, s53, 15
    s_lshl_b32 s53, s53, 17
    s_add_u32 m0, s45, 24576
    s_add_u32 s53, s53, s46
    buffer_load_dwordx4 v128, s[4:7], s53 offen sc1 lds
    v_mfma_f32_32x32x16_bf16 v[48:63], v[104:107], v[116:119], v[48:63]
    ds_read_b64_tr_b16 v[88:89], v8 offset:7232
    ds_read_b64_tr_b16 v[90:91], v8 offset:8128
    ds_read_b64_tr_b16 v[92:93], v8 offset:7264
    v_lshlrev_b32 v140, 16, v117
    v_and_b32 v141, s72, v117
    v_add_f32 v12, v12, v140
    v_mfma_f32_32x32x16_bf16 v[64:79], v[108:111], v[116:119], v[64:79]
    ds_read_b64_tr_b16 v[94:95], v8 offset:8160
    v_add_f32 v13, v13, v141
    v_fmac_f32 v14, v140, v140
    v_fmac_f32 v15, v141, v141
    s_waitcnt lgkmcnt(8)
    s_waitcnt lgkmcnt(6)
    v_mfma_f32_32x32x16_bf16 v[16:31], v[80:83], v[112:115], v[16:31]
    ds_read_b64_tr_b16 v[116:117], v136 offset:36864
    ds_read_b64_tr_b16 v[118:119], v136 offset:37888
    ds_read_b64_tr_b16 v[96:97], v8 offset:10752
    ds_read_b64_tr_b16 v[98:99], v8 offset:11648
    ds_read_b64_tr_b16 v[100:101], v8 offset:10784
    v_lshlrev_b32 v138, 16, v112
    v_and_b32 v139, s72, v112
    v_add_f32 v12, v12, v138
    s_waitcnt lgkmcnt(9)
    v_mfma_f32_32x32x16_bf16 v[32:47], v[84:87], v[112:115], v[32:47]
    ds_read_b64_tr_b16 v[102:103], v8 offset:11680
    ds_read_b64_tr_b16 v[104:105], v8 offset:10816
    ds_read_b64_tr_b16 v[106:107], v8 offset:11712
    ds_read_b64_tr_b16 v[108:109], v8 offset:10848
    ds_read_b64_tr_b16 v[110:111], v8 offset:11744
    v_add_f32 v13, v13, v139
    v_fmac_f32 v14, v138, v138
    v_fmac_f32 v15, v139, v139
    s_add_u32 m0, s45, 25600
    s_add_u32 s53, s53, 16384
    buffer_load_dwordx4 v128, s[4:7], s53 offen sc1 lds
    s_waitcnt lgkmcnt(12)
    v_mfma_f32_32x32x16_bf16 v[48:63], v[88:91], v[112:115], v[48:63]
    v_lshlrev_b32 v140, 16, v113
    v_and_b32 v141, s72, v113
    v_add_f32 v12, v12, v140
    s_waitcnt lgkmcnt(10)
    v_mfma_f32_32x32x16_bf16 v[64:79], v[92:95], v[112:115], v[64:79]
    v_add_f32 v13, v13, v141
    v_fmac_f32 v14, v140, v140
    v_fmac_f32 v15, v141, v141
    s_waitcnt vmcnt(7) lgkmcnt(0)
    s_barrier
    s_waitcnt vmcnt(4)
    s_mov_b32 s77, 0
    s_branch l_cc40
l_cl39:
    buffer_load_dword v151, v150, s[4:7], s43 offen sc1
    s_waitcnt vmcnt(0)
l_cc40:
    v_cmp_ne_u32 vcc, s69, v151
    s_nop 1
    s_cmp_eq_u64 vcc, 0
    s_cbranch_scc1 l_cd41
    s_add_u32 s77, s77, 1
    s_cmp_lt_u32 s77, 20000
    s_cbranch_scc1 l_cl39
l_cd41:
    v_min_u32 v150, 223, v0
    v_lshlrev_b32 v150, 2, v150
    s_add_u32 s43, s42, 3584
    buffer_load_dword v142, v150, s[4:7], s42 offen offset:0 sc1
    buffer_load_dword v143, v150, s[4:7], s42 offen offset:896 sc1
    buffer_load_dword v144, v150, s[4:7], s42 offen offset:1792 sc1
    buffer_load_dword v145, v150, s[4:7], s42 offen offset:2688 sc1
    buffer_load_dword v146, v150, s[4:7], s43 offen offset:0 sc1
    buffer_load_dword v147, v150, s[4:7], s43 offen offset:896 sc1
    buffer_load_dword v148, v150, s[4:7], s43 offen offset:1792 sc1
    buffer_load_dword v149, v150, s[4:7], s43 offen offset:2688 sc1
    v_mfma_f32_32x32x16_bf16 v[16:31], v[96:99], v[116:119], v[16:31]
    ds_read_b64_tr_b16 v[112:113], v136 offset:0
    ds_read_b64_tr_b16 v[114:115], v136 offset:1024
    ds_read_b64_tr_b16 v[80:81], v8 offset:14336
    v_lshlrev_b32 v138, 16, v116
    v_and_b32 v139, s72, v116
    v_add_f32 v12, v12, v138
    v_mfma_f32_32x32x16_bf16 v[32:47], v[100:103], v[116:119], v[32:47]
    ds_read_b64_tr_b16 v[82:83], v8 offset:15232
    ds_read_b64_tr_b16 v[84:85], v8 offset:14368
    ds_read_b64_tr_b16 v[86:87], v8 offset:15264
    v_add_f32 v13, v13, v139
    v_fmac_f32 v14, v138, v138
    v_fmac_f32 v15, v139, v139
    s_add_u32 s53, s47, 14
    s_and_b32 s53, s53, 15
    s_lshl_b32 s53, s53, 17
    s_add_u32 m0, s45, 32768
    s_add_u32 s53, s53, s46
    buffer_load_dwordx4 v128, s[4:7], s53 offen sc1 lds
    v_mfma_f32_32x32x16_bf16 v[48:63], v[104:107], v[116:119], v[48:63]
    ds_read_b64_tr_b16 v[88:89], v8 offset:14400
    ds_read_b64_tr_b16 v[90:91], v8 offset:15296
    ds_read_b64_tr_b16 v[92:93], v8 offset:14432
    v_lshlrev_b32 v140, 16, v117
    v_and_b32 v141, s72, v117
    v_add_f32 v12, v12, v140
    v_mfma_f32_32x32x16_bf16 v[64:79], v[108:111], v[116:119], v[64:79]
    ds_read_b64_tr_b16 v[94:95], v8 offset:15328
    v_add_f32 v13, v13, v141
    v_fmac_f32 v14, v140, v140
    v_fmac_f32 v15, v141, v141
    s_waitcnt lgkmcnt(8)
    s_waitcnt lgkmcnt(6)
    v_mfma_f32_32x32x16_bf16 v[16:31], v[80:83], v[112:115], v[16:31]
    ds_read_b64_tr_b16 v[116:117], v136 offset:4096
    ds_read_b64_tr_b16 v[118:119], v136 offset:5120
    ds_read_b64_tr_b16 v[96:97], v8 offset:17920
    ds_read_b64_tr_b16 v[98:99], v8 offset:18816
    ds_read_b64_tr_b16 v[100:101], v8 offset:17952
    v_lshlrev_b32 v138, 16, v112
    v_and_b32 v139, s72, v112
    v_add_f32 v12, v12, v138
    s_waitcnt lgkmcnt(9)
    v_mfma_f32_32x32x16_bf16 v[32:47], v[84:87], v[112:115], v[32:47]
    ds_read_b64_tr_b16 v[102:103], v8 offset:18848
    ds_read_b64_tr_b16 v[104:105], v8 offset:17984
    ds_read_b64_tr_b16 v[106:107], v8 offset:18880
    ds_read_b64_tr_b16 v[108:109], v8 offset:18016
    ds_read_b64_tr_b16 v[110:111], v8 offset:18912
    v_add_f32 v13, v13, v139
    v_fmac_f32 v14, v138, v138
    v_fmac_f32 v15, v139, v139
    s_add_u32 m0, s45, 33792
    s_add_u32 s53, s53, 16384
    buffer_load_dwordx4 v128, s[4:7], s53 offen sc1 lds
    s_waitcnt lgkmcnt(12)
    v_mfma_f32_32x32x16_bf16 v[48:63], v[88:91], v[112:115], v[48:63]
    v_lshlrev_b32 v140, 16, v113
    v_and_b32 v141, s72, v113
    v_add_f32 v12, v12, v140
    s_waitcnt lgkmcnt(10)
    v_mfma_f32_32x32x16_bf16 v[64:79], v[92:95], v[112:115], v[64:79]
    v_add_f32 v13, v13, v141
    v_fmac_f32 v14, v140, v140
    v_fmac_f32 v15, v141, v141
    s_waitcnt vmcnt(15) lgkmcnt(0)
    s_barrier
    v_mfma_f32_32x32x16_bf16 v[16:31], v[96:99], v[116:119], v[16:31]
    ds_read_b64_tr_b16 v[112:113], v136 offset:8192
    ds_read_b64_tr_b16 v[114:115], v136 offset:9216
    ds_read_b64_tr_b16 v[80:81], v8 offset:21504
    v_lshlrev_b32 v138, 16, v116
    v_and_b32 v139, s72, v116
    v_add_f32 v12, v12, v138
    v_mfma_f32_32x32x16_bf16 v[32:47], v[100:103], v[116:119], v[32:47]
    ds_read_b64_tr_b16 v[82:83], v8 offset:22400
    ds_read_b64_tr_b16 v[84:85], v8 offset:21536
    ds_read_b64_tr_b16 v[86:87], v8 offset:22432
    v_add_f32 v13, v13, v139
    v_fmac_f32 v14, v138, v138
    v_fmac_f32 v15, v139, v139
    s_add_u32 s53, s47, 15
    s_and_b32 s53, s53, 15
    s_lshl_b32 s53, s53, 17
    s_add_u32 m0, s45, 0
    s_add_u32 s53, s53, s46
    buffer_load_dwordx4 v128, s[4:7], s53 offen sc1 lds
    v_mfma_f32_32x32x16_bf16 v[48:63], v[104:107], v[116:119], v[48:63]
    ds_read_b64_tr_b16 v[88:89], v8 offset:21568
    ds_read_b64_tr_b16 v[90:91], v8 offset:22464
    ds_read_b64_tr_b16 v[92:93], v8 offset:21600
    v_lshlrev_b32 v140, 16, v117
    v_and_b32 v141, s72, v117
    v_add_f32 v12, v12, v140
    v_mfma_f32_32x32x16_bf16 v[64:79], v[108:111], v[116:119], v[64:79]
    ds_read_b64_tr_b16 v[94:95], v8 offset:22496
    v_add_f32 v13, v13, v141
    v_fmac_f32 v14, v140, v140
    v_fmac_f32 v15, v141, v141
    s_waitcnt lgkmcnt(8)
    s_waitcnt lgkmcnt(6)
    v_mfma_f32_32x32x16_bf16 v[16:31], v[80:83], v[112:115], v[16:31]
    ds_read_b64_tr_b16 v[116:117], v136 offset:12288
    ds_read_b64_tr_b16 v[118:119], v136 offset:13312
    ds_read_b64_tr_b16 v[96:97], v8 offset:25088
    ds_read_b64_tr_b16 v[98:99], v8 offset:25984
    ds_read_b64_tr_b16 v[100:101], v8 offset:25120
    v_lshlrev_b32 v138, 16, v112
    v_and_b32 v139, s72, v112
    v_add_f32 v12, v12, v138
    s_waitcnt lgkmcnt(9)
    v_mfma_f32_32x32x16_bf16 v[32:47], v[84:87], v[112:115], v[32:47]
    ds_read_b64_tr_b16 v[102:103], v8 offset:26016
    ds_read_b64_tr_b16 v[104:105], v8 offset:25152
    ds_read_b64_tr_b16 v[106:107], v8 offset:26048
    ds_read_b64_tr_b16 v[108:109], v8 offset:25184
    ds_read_b64_tr_b16 v[110:111], v8 offset:26080
    v_add_f32 v13, v13, v139
    v_fmac_f32 v14, v138, v138
    v_fmac_f32 v15, v139, v139
    s_add_u32 m0, s45, 1024
    s_add_u32 s53, s53, 16384
    buffer_load_dwordx4 v128, s[4:7], s53 offen sc1 lds
    s_waitcnt lgkmcnt(12)
    v_mfma_f32_32x32x16_bf16 v[48:63], v[88:91], v[112:115], v[48:63]
    v_lshlrev_b32 v140, 16, v113
    v_and_b32 v141, s72, v113
    v_add_f32 v12, v12, v140
    s_waitcnt lgkmcnt(10)
    v_mfma_f32_32x32x16_bf16 v[64:79], v[92:95], v[112:115], v[64:79]
    v_add_f32 v13, v13, v141
    v_fmac_f32 v14, v140, v140
    v_fmac_f32 v15, v141, v141
    s_waitcnt vmcnt(14) lgkmcnt(0)
    s_barrier
    v_mfma_f32_32x32x16_bf16 v[16:31], v[96:99], v[116:119], v[16:31]
    ds_read_b64_tr_b16 v[112:113], v136 offset:16384
    ds_read_b64_tr_b16 v[114:115], v136 offset:17408
    ds_read_b64_tr_b16 v[80:81], v8 offset:28672
    v_lshlrev_b32 v138, 16, v116
    v_and_b32 v139, s72, v116
    v_add_f32 v12, v12, v138
    v_mfma_f32_32x32x16_bf16 v[32:47], v[100:103], v[116:119], v[32:47]
    ds_read_b64_tr_b16 v[82:83], v8 offset:29568
    ds_read_b64_tr_b16 v[84:85], v8 offset:28704
    ds_read_b64_tr_b16 v[86:87], v8 offset:29600
    v_add_f32 v13, v13, v139
    v_fmac_f32 v14, v138, v138
    v_fmac_f32 v15, v139, v139
    v_mfma_f32_32x32x16_bf16 v[48:63], v[104:107], v[116:119], v[48:63]
    ds_read_b64_tr_b16 v[88:89], v8 offset:28736
    ds_read_b64_tr_b16 v[90:91], v8 offset:29632
    ds_read_b64_tr_b16 v[92:93], v8 offset:28768
    v_lshlrev_b32 v140, 16, v117
    v_and_b32 v141, s72, v117
    v_add_f32 v12, v12, v140
    v_mfma_f32_32x32x16_bf16 v[64:79], v[108:111], v[116:119], v[64:79]
    ds_read_b64_tr_b16 v[94:95], v8 offset:29664
    v_add_f32 v13, v13, v141
    v_fmac_f32 v14, v140, v140
    v_fmac_f32 v15, v141, v141
    s_waitcnt lgkmcnt(8)
    s_waitcnt lgkmcnt(6)
    v_mfma_f32_32x32x16_bf16 v[16:31], v[80:83], v[112:115], v[16:31]
    ds_read_b64_tr_b16 v[116:117], v136 offset:20480
    ds_read_b64_tr_b16 v[118:119], v136 offset:21504
    ds_read_b64_tr_b16 v[96:97], v8 offset:32256
    ds_read_b64_tr_b16 v[98:99], v8 offset:33152
    ds_read_b64_tr_b16 v[100:101], v8 offset:32288
    v_lshlrev_b32 v138, 16, v112
    v_and_b32 v139, s72, v112
    v_add_f32 v12, v12, v138
    s_waitcnt lgkmcnt(9)
    v_mfma_f32_32x32x16_bf16 v[32:47], v[84:87], v[112:115], v[32:47]
    ds_read_b64_tr_b16 v[102:103], v8 offset:33184
    ds_read_b64_tr_b16 v[104:105], v8 offset:32320
    ds_read_b64_tr_b16 v[106:107], v8 offset:33216
    ds_read_b64_tr_b16 v[108:109], v8 offset:32352
    ds_read_b64_tr_b16 v[110:111], v8 offset:33248
    v_add_f32 v13, v13, v139
    v_fmac_f32 v14, v138, v138
    v_fmac_f32 v15, v139, v139
    s_waitcnt lgkmcnt(12)
    v_mfma_f32_32x32x16_bf16 v[48:63], v[88:91], v[112:115], v[48:63]
    v_lshlrev_b32 v140, 16, v113
    v_and_b32 v141, s72, v113
    v_add_f32 v12, v12, v140
    s_waitcnt lgkmcnt(10)
    v_mfma_f32_32x32x16_bf16 v[64:79], v[92:95], v[112:115], v[64:79]
    v_add_f32 v13, v13, v141
    v_fmac_f32 v14, v140, v140
    v_fmac_f32 v15, v141, v141
    s_waitcnt vmcnt(12) lgkmcnt(0)
    s_barrier
    v_mfma_f32_32x32x16_bf16 v[16:31], v[96:99], v[116:119], v[16:31]
    ds_read_b64_tr_b16 v[112:113], v136 offset:24576
    ds_read_b64_tr_b16 v[114:115], v136 offset:25600
    ds_read_b64_tr_b16 v[80:81], v8 offset:35840
    v_lshlrev_b32 v138, 16, v116
    v_and_b32 v139, s72, v116
    v_add_f32 v12, v12, v138
    v_mfma_f32_32x32x16_bf16 v[32:47], v[100:103], v[116:119], v[32:47]
    ds_read_b64_tr_b16 v[82:83], v8 offset:36736
    ds_read_b64_tr_b16 v[84:85], v8 offset:35872
    ds_read_b64_tr_b16 v[86:87], v8 offset:36768
    v_add_f32 v13, v13, v139
    v_fmac_f32 v14, v138, v138
    v_fmac_f32 v15, v139, v139
    v_mfma_f32_32x32x16_bf16 v[48:63], v[104:107], v[116:119], v[48:63]
    ds_read_b64_tr_b16 v[88:89], v8 offset:35904
    ds_read_b64_tr_b16 v[90:91], v8 offset:36800
    ds_read_b64_tr_b16 v[92:93], v8 offset:35936
    v_lshlrev_b32 v140, 16, v117
    v_and_b32 v141, s72, v117
    v_add_f32 v12, v12, v140
    v_mfma_f32_32x32x16_bf16 v[64:79], v[108:111], v[116:119], v[64:79]
    ds_read_b64_tr_b16 v[94:95], v8 offset:36832
    v_add_f32 v13, v13, v141
    v_fmac_f32 v14, v140, v140
    v_fmac_f32 v15, v141, v141
    s_waitcnt lgkmcnt(8)
    s_waitcnt lgkmcnt(6)
    v_mfma_f32_32x32x16_bf16 v[16:31], v[80:83], v[112:115], v[16:31]
    ds_read_b64_tr_b16 v[116:117], v136 offset:28672
    ds_read_b64_tr_b16 v[118:119], v136 offset:29696
    ds_read_b64_tr_b16 v[96:97], v8 offset:39424
    ds_read_b64_tr_b16 v[98:99], v8 offset:40320
    ds_read_b64_tr_b16 v[100:101], v8 offset:39456
    v_lshlrev_b32 v138, 16, v112
    v_and_b32 v139, s72, v112
    v_add_f32 v12, v12, v138
    s_waitcnt lgkmcnt(9)
    v_mfma_f32_32x32x16_bf16 v[32:47], v[84:87], v[112:115], v[32:47]
    ds_read_b64_tr_b16 v[102:103], v8 offset:40352
    ds_read_b64_tr_b16 v[104:105], v8 offset:39488
    ds_read_b64_tr_b16 v[106:107], v8 offset:40384
    ds_read_b64_tr_b16 v[108:109], v8 offset:39520
    ds_read_b64_tr_b16 v[110:111], v8 offset:40416
    v_add_f32 v13, v13, v139
    v_fmac_f32 v14, v138, v138
    v_fmac_f32 v15, v139, v139
    s_waitcnt lgkmcnt(12)
    v_mfma_f32_32x32x16_bf16 v[48:63], v[88:91], v[112:115], v[48:63]
    v_lshlrev_b32 v140, 16, v113
    v_and_b32 v141, s72, v113
    v_add_f32 v12, v12, v140
    s_waitcnt lgkmcnt(10)
    v_mfma_f32_32x32x16_bf16 v[64:79], v[92:95], v[112:115], v[64:79]
    v_add_f32 v13, v13, v141
    v_fmac_f32 v14, v140, v140
    v_fmac_f32 v15, v141, v141
    s_waitcnt vmcnt(2) lgkmcnt(0)
    s_barrier
    v_mfma_f32_32x32x16_bf16 v[16:31], v[96:99], v[116:119], v[16:31]
    ds_read_b64_tr_b16 v[112:113], v136 offset:32768
    ds_read_b64_tr_b16 v[114:115], v136 offset:33792
    ds_read_b64_tr_b16 v[80:81], v8 offset:43008
    v_lshlrev_b32 v138, 16, v116
    v_and_b32 v139, s72, v116
    v_add_f32 v12, v12, v138
    v_mfma_f32_32x32x16_bf16 v[32:47], v[100:103], v[116:119], v[32:47]
    ds_read_b64_tr_b16 v[82:83], v8 offset:43904
    ds_read_b64_tr_b16 v[84:85], v8 offset:43040
    ds_read_b64_tr_b16 v[86:87], v8 offset:43936
    v_add_f32 v13, v13, v139
    v_fmac_f32 v14, v138, v138
    v_fmac_f32 v15, v139, v139
    v_mfma_f32_32x32x16_bf16 v[48:63], v[104:107], v[116:119], v[48:63]
    ds_read_b64_tr_b16 v[88:89], v8 offset:43072
    ds_read_b64_tr_b16 v[90:91], v8 offset:43968
    ds_read_b64_tr_b16 v[92:93], v8 offset:43104
    v_lshlrev_b32 v140, 16, v117
    v_and_b32 v141, s72, v117
    v_add_f32 v12, v12, v140
    v_mfma_f32_32x32x16_bf16 v[64:79], v[108:111], v[116:119], v[64:79]
    ds_read_b64_tr_b16 v[94:95], v8 offset:44000
    v_add_f32 v13, v13, v141
    v_fmac_f32 v14, v140, v140
    v_fmac_f32 v15, v141, v141
    s_waitcnt lgkmcnt(8)
    s_waitcnt lgkmcnt(6)
    v_mfma_f32_32x32x16_bf16 v[16:31], v[80:83], v[112:115], v[16:31]
    ds_read_b64_tr_b16 v[116:117], v136 offset:36864
    ds_read_b64_tr_b16 v[118:119], v136 offset:37888
    ds_read_b64_tr_b16 v[96:97], v8 offset:46592
    ds_read_b64_tr_b16 v[98:99], v8 offset:47488
    ds_read_b64_tr_b16 v[100:101], v8 offset:46624
    v_lshlrev_b32 v138, 16, v112
    v_and_b32 v139, s72, v112
    v_add_f32 v12, v12, v138
    s_waitcnt lgkmcnt(9)
    v_mfma_f32_32x32x16_bf16 v[32:47], v[84:87], v[112:115], v[32:47]
    ds_read_b64_tr_b16 v[102:103], v8 offset:47520
    ds_read_b64_tr_b16 v[104:105], v8 offset:46656
    ds_read_b64_tr_b16 v[106:107], v8 offset:47552
    ds_read_b64_tr_b16 v[108:109], v8 offset:46688
    ds_read_b64_tr_b16 v[110:111], v8 offset:47584
    v_add_f32 v13, v13, v139
    v_fmac_f32 v14, v138, v138
    v_fmac_f32 v15, v139, v139
    s_waitcnt lgkmcnt(12)
    v_mfma_f32_32x32x16_bf16 v[48:63], v[88:91], v[112:115], v[48:63]
    v_lshlrev_b32 v140, 16, v113
    v_and_b32 v141, s72, v113
    v_add_f32 v12, v12, v140
    s_waitcnt lgkmcnt(10)
    v_mfma_f32_32x32x16_bf16 v[64:79], v[92:95], v[112:115], v[64:79]
    v_add_f32 v13, v13, v141
    v_fmac_f32 v14, v140, v140
    v_fmac_f32 v15, v141, v141
    s_waitcnt vmcnt(0) lgkmcnt(0)
    s_barrier
    v_mfma_f32_32x32x16_bf16 v[16:31], v[96:99], v[116:119], v[16:31]
    ds_read_b64_tr_b16 v[112:113], v136 offset:0
    ds_read_b64_tr_b16 v[114:115], v136 offset:1024
    ds_read_b64_tr_b16 v[80:81], v8 offset:50176
    v_lshlrev_b32 v138, 16, v116
    v_and_b32 v139, s72, v116
    v_add_f32 v12, v12, v138
    v_mfma_f32_32x32x16_bf16 v[32:47], v[100:103], v[116:119], v[32:47]
    ds_read_b64_tr_b16 v[82:83], v8 offset:51072
    ds_read_b64_tr_b16 v[84:85], v8 offset:50208
    ds_read_b64_tr_b16 v[86:87], v8 offset:51104
    v_add_f32 v13, v13, v139
    v_fmac_f32 v14, v138, v138
    v_fmac_f32 v15, v139, v139
    v_mfma_f32_32x32x16_bf16 v[48:63], v[104:107], v[116:119], v[48:63]
    ds_read_b64_tr_b16 v[88:89], v8 offset:50240
    ds_read_b64_tr_b16 v[90:91], v8 offset:51136
    ds_read_b64_tr_b16 v[92:93], v8 offset:50272
    v_lshlrev_b32 v140, 16, v117
    v_and_b32 v141, s72, v117
    v_add_f32 v12, v12, v140
    v_mfma_f32_32x32x16_bf16 v[64:79], v[108:111], v[116:119], v[64:79]
    ds_read_b64_tr_b16 v[94:95], v8 offset:51168
    v_add_f32 v13, v13, v141
    v_fmac_f32 v14, v140, v140
    v_fmac_f32 v15, v141, v141
    s_waitcnt lgkmcnt(8)
    s_waitcnt lgkmcnt(6)
    v_mfma_f32_32x32x16_bf16 v[16:31], v[80:83], v[112:115], v[16:31]
    ds_read_b64_tr_b16 v[116:117], v136 offset:4096
    ds_read_b64_tr_b16 v[118:119], v136 offset:5120
    ds_read_b64_tr_b16 v[96:97], v8 offset:53760
    ds_read_b64_tr_b16 v[98:99], v8 offset:54656
    ds_read_b64_tr_b16 v[100:101], v8 offset:53792
    v_lshlrev_b32 v138, 16, v112
    v_and_b32 v139, s72, v112
    v_add_f32 v12, v12, v138
    s_waitcnt lgkmcnt(9)
    v_mfma_f32_32x32x16_bf16 v[32:47], v[84:87], v[112:115], v[32:47]
    ds_read_b64_tr_b16 v[102:103], v8 offset:54688
    ds_read_b64_tr_b16 v[104:105], v8 offset:53824
    ds_read_b64_tr_b16 v[106:107], v8 offset:54720
    ds_read_b64_tr_b16 v[108:109], v8 offset:53856
    ds_read_b64_tr_b16 v[110:111], v8 offset:54752
    v_add_f32 v13, v13, v139
    v_fmac_f32 v14, v138, v138
    v_fmac_f32 v15, v139, v139
    s_waitcnt lgkmcnt(12)
    v_mfma_f32_32x32x16_bf16 v[48:63], v[88:91], v[112:115], v[48:63]
    v_lshlrev_b32 v140, 16, v113
    v_and_b32 v141, s72, v113
    v_add_f32 v12, v12, v140
    s_waitcnt lgkmcnt(10)
    v_mfma_f32_32x32x16_bf16 v[64:79], v[92:95], v[112:115], v[64:79]
    v_add_f32 v13, v13, v141
    v_fmac_f32 v14, v140, v140
    v_fmac_f32 v15, v141, v141
    s_waitcnt lgkmcnt(8)
    s_waitcnt lgkmcnt(6)
    v_mfma_f32_32x32x16_bf16 v[16:31], v[96:99], v[116:119], v[16:31]
    v_lshlrev_b32 v138, 16, v116
    v_and_b32 v139, s72, v116
    v_add_f32 v12, v12, v138
    s_waitcnt lgkmcnt(4)
    v_mfma_f32_32x32x16_bf16 v[32:47], v[100:103], v[116:119], v[32:47]
    v_add_f32 v13, v13, v139
    v_fmac_f32 v14, v138, v138
    v_fmac_f32 v15, v139, v139
    s_waitcnt lgkmcnt(2)
    v_mfma_f32_32x32x16_bf16 v[48:63], v[104:107], v[116:119], v[48:63]
    v_lshlrev_b32 v140, 16, v117
    v_and_b32 v141, s72, v117
    v_add_f32 v12, v12, v140
    s_waitcnt lgkmcnt(0)
    v_mfma_f32_32x32x16_bf16 v[64:79], v[108:111], v[116:119], v[64:79]
    v_add_f32 v13, v13, v141
    v_fmac_f32 v14, v140, v140
    v_fmac_f32 v15, v141, v141
    v_add_f32 v12, v12, v13
    v_add_f32 v13, v14, v15
    v_mov_b32 v14, v12
    v_mov_b32 v15, v13
    s_nop 0
    v_permlane32_swap_b32 v12, v14
    v_permlane32_swap_b32 v13, v15
    v_add_f32 v12, v12, v14
    v_add_f32 v13, v13, v15
    v_and_b32 v8, 31, v2
    v_lshlrev_b32 v8, 3, v8
    s_lshl_b32 s75, s73, 9
    s_add_u32 s75, s75, 156800
    v_add_u32 v8, s75, v8
    ds_write_b64 v8, v[12:13] offset:0
    s_waitcnt vmcnt(4)
    v_add_f32 v142, v142, v143
    v_add_f32 v144, v144, v145
    v_add_f32 v146, v146, v147
    v_add_f32 v148, v148, v149
    v_add_f32 v142, v142, v144
    v_add_f32 v146, v146, v148
    v_add_f32 v142, v142, v146
    v_add_u32 v150, 155776, v150
    ds_write_b32 v150, v142
    s_waitcnt lgkmcnt(0)
    s_barrier
    s_lshr_b32 s75, s67, 3
    s_lshl_b32 s76, s66, 2
    s_add_u32 s75, s75, s76
    s_lshl_b32 s75, s75, 7
    s_and_b32 s76, s67, 7
    s_lshl_b32 s76, s76, 2
    s_add_u32 s76, s76, s73
    s_lshl_b32 s76, s76, 16
    s_add_u32 s75, s75, s76
    s_add_u32 s75, s75, 4194304
    v_lshrrev_b32 v9, 2, v2
    v_and_b32 v10, 3, v2
    v_lshlrev_b32 v10, 4, v10
    v_lshl_add_u32 v9, v9, 12, v10
    s_lshl_b32 s76, s3, 10
    s_add_u32 m0, s76, 139392
    s_nop 0
    buffer_load_dwordx4 v9, s[4:7], s75 offen sc1 lds
    ds_read_b64 v[14:15], v8 offset:256
    ds_read_b128 v[80:83], v137 offset:0
    ds_read_b128 v[84:87], v137 offset:16
    ds_read_b128 v[88:91], v137 offset:32
    ds_read_b128 v[92:95], v137 offset:48
    s_lshl_b32 s48, s41, 2
    s_add_u32 s48, s48, s73
    s_mul_i32 s48, s48, 112
    s_mul_i32 s49, s40, 7
    s_add_u32 s48, s48, s49
    s_add_u32 s48, s48, 0
    s_lshl_b32 s48, s48, 10
    s_add_u32 s48, s48, 8388608
    s_waitcnt lgkmcnt(4)
    v_add_f32 v12, v12, v14
    v_add_f32 v13, v13, v15
    v_mul_f32 v12, 0x3b000000, v12
    v_mul_f32 v14, 0x3b000000, v13
    v_fma_f32 v14, -v12, v12, v14
    v_max_f32 v14, 0, v14
    v_add_f32 v14, 0x3727c5ac, v14
    v_rsq_f32 v13, v14
    s_nop 0
    v_mul_f32 v8, 0xbfb8aa3b, v13
    v_sub_f32 v12, 0, v12
    ds_read_b128 v[96:99], v137 offset:128
    ds_read_b128 v[100:103], v137 offset:144
    ds_read_b128 v[104:107], v137 offset:160
    ds_read_b128 v[108:111], v137 offset:176
    s_waitcnt lgkmcnt(4)
    v_pk_fma_f32 v[16:17], v[80:81], v[12:13], v[16:17] op_sel_hi:[1,0,1]
    v_pk_fma_f32 v[18:19], v[82:83], v[12:13], v[18:19] op_sel_hi:[1,0,1]
    v_pk_fma_f32 v[20:21], v[84:85], v[12:13], v[20:21] op_sel_hi:[1,0,1]
    v_pk_fma_f32 v[22:23], v[86:87], v[12:13], v[22:23] op_sel_hi:[1,0,1]
    v_pk_fma_f32 v[24:25], v[88:89], v[12:13], v[24:25] op_sel_hi:[1,0,1]
    v_pk_fma_f32 v[26:27], v[90:91], v[12:13], v[26:27] op_sel_hi:[1,0,1]
    v_pk_fma_f32 v[28:29], v[92:93], v[12:13], v[28:29] op_sel_hi:[1,0,1]
    v_pk_fma_f32 v[30:31], v[94:95], v[12:13], v[30:31] op_sel_hi:[1,0,1]
    v_pk_mul_f32 v[112:113], v[16:17], v[8:9] op_sel_hi:[1,0]
    v_pk_mul_f32 v[114:115], v[18:19], v[8:9] op_sel_hi:[1,0]
    v_pk_mul_f32 v[116:117], v[20:21], v[8:9] op_sel_hi:[1,0]
    v_pk_mul_f32 v[118:119], v[22:23], v[8:9] op_sel_hi:[1,0]
    v_exp_f32 v112, v112
    v_exp_f32 v113, v113
    v_exp_f32 v114, v114
    v_exp_f32 v115, v115
    v_exp_f32 v116, v116
    v_exp_f32 v117, v117
    v_exp_f32 v118, v118
    v_exp_f32 v119, v119
    v_pk_mul_f32 v[16:17], v[16:17], v[24:25]
    v_pk_mul_f32 v[18:19], v[18:19], v[26:27]
    v_pk_mul_f32 v[20:21], v[20:21], v[28:29]
    v_pk_mul_f32 v[22:23], v[22:23], v[30:31]
    v_pk_fma_f32 v[112:113], v[112:113], v[14:15], v[14:15] op_sel_hi:[1,0,0]
    v_pk_fma_f32 v[114:115], v[114:115], v[14:15], v[14:15] op_sel_hi:[1,0,0]
    v_pk_fma_f32 v[116:117], v[116:117], v[14:15], v[14:15] op_sel_hi:[1,0,0]
    v_pk_fma_f32 v[118:119], v[118:119], v[14:15], v[14:15] op_sel_hi:[1,0,0]
    v_rcp_f32 v112, v112
    v_rcp_f32 v113, v113
    v_rcp_f32 v114, v114
    v_rcp_f32 v115, v115
    v_rcp_f32 v116, v116
    v_rcp_f32 v117, v117
    v_rcp_f32 v118, v118
    v_rcp_f32 v119, v119
    v_pk_mul_f32 v[16:17], v[16:17], v[112:113]
    v_pk_mul_f32 v[18:19], v[18:19], v[114:115]
    v_pk_mul_f32 v[20:21], v[20:21], v[116:117]
    v_pk_mul_f32 v[22:23], v[22:23], v[118:119]
    v_cvt_pk_bf16_f32 v120, v16, v17
    v_cvt_pk_bf16_f32 v121, v18, v19
    v_cvt_pk_bf16_f32 v122, v20, v21
    v_cvt_pk_bf16_f32 v123, v22, v23
    buffer_store_dwordx4 v[120:123], v3, s[4:7], s48 offen offset:0 sc1
    ds_read_b128 v[80:83], v137 offset:256
    ds_read_b128 v[84:87], v137 offset:272
    ds_read_b128 v[88:91], v137 offset:288
    ds_read_b128 v[92:95], v137 offset:304
    s_waitcnt lgkmcnt(4)
    v_pk_fma_f32 v[32:33], v[96:97], v[12:13], v[32:33] op_sel_hi:[1,0,1]
    v_pk_fma_f32 v[34:35], v[98:99], v[12:13], v[34:35] op_sel_hi:[1,0,1]
    v_pk_fma_f32 v[36:37], v[100:101], v[12:13], v[36:37] op_sel_hi:[1,0,1]
    v_pk_fma_f32 v[38:39], v[102:103], v[12:13], v[38:39] op_sel_hi:[1,0,1]
    v_pk_fma_f32 v[40:41], v[104:105], v[12:13], v[40:41] op_sel_hi:[1,0,1]
    v_pk_fma_f32 v[42:43], v[106:107], v[12:13], v[42:43] op_sel_hi:[1,0,1]
    v_pk_fma_f32 v[44:45], v[108:109], v[12:13], v[44:45] op_sel_hi:[1,0,1]
    v_pk_fma_f32 v[46:47], v[110:111], v[12:13], v[46:47] op_sel_hi:[1,0,1]
    v_pk_mul_f32 v[112:113], v[32:33], v[8:9] op_sel_hi:[1,0]
    v_pk_mul_f32 v[114:115], v[34:35], v[8:9] op_sel_hi:[1,0]
    v_pk_mul_f32 v[116:117], v[36:37], v[8:9] op_sel_hi:[1,0]
    v_pk_mul_f32 v[118:119], v[38:39], v[8:9] op_sel_hi:[1,0]
    v_exp_f32 v112, v112
    v_exp_f32 v113, v113
    v_exp_f32 v114, v114
    v_exp_f32 v115, v115
    v_exp_f32 v116, v116
    v_exp_f32 v117, v117
    v_exp_f32 v118, v118
    v_exp_f32 v119, v119
    v_pk_mul_f32 v[32:33], v[32:33], v[40:41]
    v_pk_mul_f32 v[34:35], v[34:35], v[42:43]
    v_pk_mul_f32 v[36:37], v[36:37], v[44:45]
    v_pk_mul_f32 v[38:39], v[38:39], v[46:47]
    v_pk_fma_f32 v[112:113], v[112:113], v[14:15], v[14:15] op_sel_hi:[1,0,0]
    v_pk_fma_f32 v[114:115], v[114:115], v[14:15], v[14:15] op_sel_hi:[1,0,0]
    v_pk_fma_f32 v[116:117], v[116:117], v[14:15], v[14:15] op_sel_hi:[1,0,0]
    v_pk_fma_f32 v[118:119], v[118:119], v[14:15], v[14:15] op_sel_hi:[1,0,0]
    v_rcp_f32 v112, v112
    v_rcp_f32 v113, v113
    v_rcp_f32 v114, v114
    v_rcp_f32 v115, v115
    v_rcp_f32 v116, v116
    v_rcp_f32 v117, v117
    v_rcp_f32 v118, v118
    v_rcp_f32 v119, v119
    v_pk_mul_f32 v[32:33], v[32:33], v[112:113]
    v_pk_mul_f32 v[34:35], v[34:35], v[114:115]
    v_pk_mul_f32 v[36:37], v[36:37], v[116:117]
    v_pk_mul_f32 v[38:39], v[38:39], v[118:119]
    v_cvt_pk_bf16_f32 v124, v32, v33
    v_cvt_pk_bf16_f32 v125, v34, v35
    v_cvt_pk_bf16_f32 v126, v36, v37
    v_cvt_pk_bf16_f32 v127, v38, v39
    buffer_store_dwordx4 v[124:127], v3, s[4:7], s48 offen offset:1024 sc1
    ds_read_b128 v[96:99], v137 offset:384
    ds_read_b128 v[100:103], v137 offset:400
    ds_read_b128 v[104:107], v137 offset:416
    ds_read_b128 v[108:111], v137 offset:432
    s_waitcnt lgkmcnt(4)
    v_pk_fma_f32 v[48:49], v[80:81], v[12:13], v[48:49] op_sel_hi:[1,0,1]
    v_pk_fma_f32 v[50:51], v[82:83], v[12:13], v[50:51] op_sel_hi:[1,0,1]
    v_pk_fma_f32 v[52:53], v[84:85], v[12:13], v[52:53] op_sel_hi:[1,0,1]
    v_pk_fma_f32 v[54:55], v[86:87], v[12:13], v[54:55] op_sel_hi:[1,0,1]
    v_pk_fma_f32 v[56:57], v[88:89], v[12:13], v[56:57] op_sel_hi:[1,0,1]
    v_pk_fma_f32 v[58:59], v[90:91], v[12:13], v[58:59] op_sel_hi:[1,0,1]
    v_pk_fma_f32 v[60:61], v[92:93], v[12:13], v[60:61] op_sel_hi:[1,0,1]
    v_pk_fma_f32 v[62:63], v[94:95], v[12:13], v[62:63] op_sel_hi:[1,0,1]
    v_pk_mul_f32 v[112:113], v[48:49], v[8:9] op_sel_hi:[1,0]
    v_pk_mul_f32 v[114:115], v[50:51], v[8:9] op_sel_hi:[1,0]
    v_pk_mul_f32 v[116:117], v[52:53], v[8:9] op_sel_hi:[1,0]
    v_pk_mul_f32 v[118:119], v[54:55], v[8:9] op_sel_hi:[1,0]
    v_exp_f32 v112, v112
    v_exp_f32 v113, v113
    v_exp_f32 v114, v114
    v_exp_f32 v115, v115
    v_exp_f32 v116, v116
    v_exp_f32 v117, v117
    v_exp_f32 v118, v118
    v_exp_f32 v119, v119
    v_pk_mul_f32 v[48:49], v[48:49], v[56:57]
    v_pk_mul_f32 v[50:51], v[50:51], v[58:59]
    v_pk_mul_f32 v[52:53], v[52:53], v[60:61]
    v_pk_mul_f32 v[54:55], v[54:55], v[62:63]
    v_pk_fma_f32 v[112:113], v[112:113], v[14:15], v[14:15] op_sel_hi:[1,0,0]
    v_pk_fma_f32 v[114:115], v[114:115], v[14:15], v[14:15] op_sel_hi:[1,0,0]
    v_pk_fma_f32 v[116:117], v[116:117], v[14:15], v[14:15] op_sel_hi:[1,0,0]
    v_pk_fma_f32 v[118:119], v[118:119], v[14:15], v[14:15] op_sel_hi:[1,0,0]
    v_rcp_f32 v112, v112
    v_rcp_f32 v113, v113
    v_rcp_f32 v114, v114
    v_rcp_f32 v115, v115
    v_rcp_f32 v116, v116
    v_rcp_f32 v117, v117
    v_rcp_f32 v118, v118
    v_rcp_f32 v119, v119
    v_pk_mul_f32 v[48:49], v[48:49], v[112:113]
    v_pk_mul_f32 v[50:51], v[50:51], v[114:115]
    v_pk_mul_f32 v[52:53], v[52:53], v[116:117]
    v_pk_mul_f32 v[54:55], v[54:55], v[118:119]
    v_cvt_pk_bf16_f32 v120, v48, v49
    v_cvt_pk_bf16_f32 v121, v50, v51
    v_cvt_pk_bf16_f32 v122, v52, v53
    v_cvt_pk_bf16_f32 v123, v54, v55
    buffer_store_dwordx4 v[120:123], v3, s[4:7], s48 offen offset:2048 sc1
    s_waitcnt lgkmcnt(0)
    v_pk_fma_f32 v[64:65], v[96:97], v[12:13], v[64:65] op_sel_hi:[1,0,1]
    v_pk_fma_f32 v[66:67], v[98:99], v[12:13], v[66:67] op_sel_hi:[1,0,1]
    v_pk_fma_f32 v[68:69], v[100:101], v[12:13], v[68:69] op_sel_hi:[1,0,1]
    v_pk_fma_f32 v[70:71], v[102:103], v[12:13], v[70:71] op_sel_hi:[1,0,1]
    v_pk_fma_f32 v[72:73], v[104:105], v[12:13], v[72:73] op_sel_hi:[1,0,1]
    v_pk_fma_f32 v[74:75], v[106:107], v[12:13], v[74:75] op_sel_hi:[1,0,1]
    v_pk_fma_f32 v[76:77], v[108:109], v[12:13], v[76:77] op_sel_hi:[1,0,1]
    v_pk_fma_f32 v[78:79], v[110:111], v[12:13], v[78:79] op_sel_hi:[1,0,1]
    v_pk_mul_f32 v[112:113], v[64:65], v[8:9] op_sel_hi:[1,0]
    v_pk_mul_f32 v[114:115], v[66:67], v[8:9] op_sel_hi:[1,0]
    v_pk_mul_f32 v[116:117], v[68:69], v[8:9] op_sel_hi:[1,0]
    v_pk_mul_f32 v[118:119], v[70:71], v[8:9] op_sel_hi:[1,0]
    v_exp_f32 v112, v112
    v_exp_f32 v113, v113
    v_exp_f32 v114, v114
    v_exp_f32 v115, v115
    v_exp_f32 v116, v116
    v_exp_f32 v117, v117
    v_exp_f32 v118, v118
    v_exp_f32 v119, v119
    v_pk_mul_f32 v[64:65], v[64:65], v[72:73]
    v_pk_mul_f32 v[66:67], v[66:67], v[74:75]
    v_pk_mul_f32 v[68:69], v[68:69], v[76:77]
    v_pk_mul_f32 v[70:71], v[70:71], v[78:79]
    v_pk_fma_f32 v[112:113], v[112:113], v[14:15], v[14:15] op_sel_hi:[1,0,0]
    v_pk_fma_f32 v[114:115], v[114:115], v[14:15], v[14:15] op_sel_hi:[1,0,0]
    v_pk_fma_f32 v[116:117], v[116:117], v[14:15], v[14:15] op_sel_hi:[1,0,0]
    v_pk_fma_f32 v[118:119], v[118:119], v[14:15], v[14:15] op_sel_hi:[1,0,0]
    v_rcp_f32 v112, v112
    v_rcp_f32 v113, v113
    v_rcp_f32 v114, v114
    v_rcp_f32 v115, v115
    v_rcp_f32 v116, v116
    v_rcp_f32 v117, v117
    v_rcp_f32 v118, v118
    v_rcp_f32 v119, v119
    v_pk_mul_f32 v[64:65], v[64:65], v[112:113]
    v_pk_mul_f32 v[66:67], v[66:67], v[114:115]
    v_pk_mul_f32 v[68:69], v[68:69], v[116:117]
    v_pk_mul_f32 v[70:71], v[70:71], v[118:119]
    v_cvt_pk_bf16_f32 v124, v64, v65
    v_cvt_pk_bf16_f32 v125, v66, v67
    v_cvt_pk_bf16_f32 v126, v68, v69
    v_cvt_pk_bf16_f32 v127, v70, v71
    buffer_store_dwordx4 v[124:127], v3, s[4:7], s48 offen offset:3072 sc1
    s_lshr_b32 s40, s67, 3
    s_lshl_b32 s41, s66, 2
    s_add_u32 s40, s40, s41
    s_lshl_b32 s40, s40, 1
    s_add_u32 s40, s40, 0
    s_mul_i32 s41, s40, 112
    s_mul_i32 s42, s73, 28
    s_add_u32 s41, s41, s42
    s_lshl_b32 s41, s41, 10
    s_add_u32 s41, s41, 8388608
    s_mul_i32 s75, s73, 14336
    v_add_u32 v8, s75, v152
    v_xor_b32 v9, 64, v8
    v_add_u32 v10, 57472, v8
    v_add_u32 v11, 57472, v9
    s_lshl_b32 s75, s73, 12
    s_add_u32 s75, s75, 123008
    v_add_u32 v12, s75, v152
    v_xor_b32 v13, 64, v12
    s_lshl_b32 s75, s73, 11
    s_add_u32 s75, s75, 0
    v_add_u32 v14, s75, v3
    s_lshl_b32 s75, s73, 13
    s_add_u32 s75, s75, 0
    v_add_u32 v15, s75, v3
    v_mov_b32 v158, v4
    v_lshrrev_b32 v4, 2, v6
    v_lshrrev_b32 v5, 1, v7
    v_lshl_add_u32 v4, v5, 3, v4
    v_lshlrev_b32 v4, 6, v4
    v_and_b32 v5, 1, v7
    v_lshl_add_u32 v4, v5, 5, v4
    v_and_b32 v5, 3, v6
    v_lshl_add_u32 v4, v5, 3, v4
    s_lshl_b32 s75, s3, 10
    s_add_u32 s75, s75, 139392
    v_add_u32 v4, s75, v4
    v_and_b32 v5, 31, v2
    v_lshlrev_b32 v5, 10, v5
    v_lshrrev_b32 v6, 5, v2
    v_lshl_add_u32 v5, v6, 4, v5
    s_lshl_b32 s43, s40, 15
    s_and_b32 s75, s67, 7
    s_lshl_b32 s75, s75, 7
    s_add_u32 s43, s43, s75
    s_lshl_b32 s75, s73, 5
    s_add_u32 s43, s43, s75
    s_barrier
    ds_read_b64_tr_b16 a[0:1], v8 offset:0
    ds_read_b64_tr_b16 a[2:3], v8 offset:512
    ds_read_b64_tr_b16 a[4:5], v9 offset:0
    ds_read_b64_tr_b16 a[6:7], v9 offset:512
    ds_read_b64_tr_b16 a[8:9], v8 offset:2048
    ds_read_b64_tr_b16 a[10:11], v8 offset:2560
    ds_read_b64_tr_b16 a[12:13], v9 offset:2048
    ds_read_b64_tr_b16 a[14:15], v9 offset:2560
    ds_read_b64_tr_b16 a[16:17], v8 offset:4096
    ds_read_b64_tr_b16 a[18:19], v8 offset:4608
    ds_read_b64_tr_b16 a[20:21], v9 offset:4096
    ds_read_b64_tr_b16 a[22:23], v9 offset:4608
    ds_read_b64_tr_b16 a[24:25], v8 offset:6144
    ds_read_b64_tr_b16 a[26:27], v8 offset:6656
    ds_read_b64_tr_b16 a[28:29], v9 offset:6144
    ds_read_b64_tr_b16 a[30:31], v9 offset:6656
    ds_read_b64_tr_b16 a[32:33], v8 offset:8192
    ds_read_b64_tr_b16 a[34:35], v8 offset:8704
    ds_read_b64_tr_b16 a[36:37], v9 offset:8192
    ds_read_b64_tr_b16 a[38:39], v9 offset:8704
    ds_read_b64_tr_b16 a[40:41], v8 offset:10240
    ds_read_b64_tr_b16 a[42:43], v8 offset:10752
    ds_read_b64_tr_b16 a[44:45], v9 offset:10240
    ds_read_b64_tr_b16 a[46:47], v9 offset:10752
    ds_read_b64_tr_b16 a[48:49], v8 offset:12288
    ds_read_b64_tr_b16 a[50:51], v8 offset:12800
    ds_read_b64_tr_b16 a[52:53], v9 offset:12288
    ds_read_b64_tr_b16 a[54:55], v9 offset:12800
    ds_read_b64_tr_b16 a[56:57], v10 offset:0
    ds_read_b64_tr_b16 a[58:59], v10 offset:512
    ds_read_b64_tr_b16 a[60:61], v11 offset:0
    ds_read_b64_tr_b16 a[62:63], v11 offset:512
    ds_read_b64_tr_b16 a[64:65], v10 offset:2048
    ds_read_b64_tr_b16 a[66:67], v10 offset:2560
    ds_read_b64_tr_b16 a[68:69], v11 offset:2048
    ds_read_b64_tr_b16 a[70:71], v11 offset:2560
    ds_read_b64_tr_b16 a[72:73], v10 offset:4096
    ds_read_b64_tr_b16 a[74:75], v10 offset:4608
    ds_read_b64_tr_b16 a[76:77], v11 offset:4096
    ds_read_b64_tr_b16 a[78:79], v11 offset:4608
    ds_read_b64_tr_b16 a[80:81], v10 offset:6144
    ds_read_b64_tr_b16 a[82:83], v10 offset:6656
    ds_read_b64_tr_b16 a[84:85], v11 offset:6144
    ds_read_b64_tr_b16 a[86:87], v11 offset:6656
    ds_read_b64_tr_b16 a[88:89], v10 offset:8192
    ds_read_b64_tr_b16 a[90:91], v10 offset:8704
    ds_read_b64_tr_b16 a[92:93], v11 offset:8192
    ds_read_b64_tr_b16 a[94:95], v11 offset:8704
    s_mul_i32 s45, s73, 14336
    s_mul_i32 s46, s73, 458752
    s_waitcnt vmcnt(0) lgkmcnt(0)
    s_barrier
    s_cmp_eq_u32 s3, 0
    s_cbranch_scc0 l_w342
    s_lshl_b32 s75, s66, 5
    s_add_u32 s75, s75, s67
    s_or_b32 s76, s68, 112
    v_mov_b32 v20, s76
    v_mov_b32 v21, 0
    s_mov_b64 exec, 1
    s_lshl_b32 s75, s75, 7
    s_add_u32 s75, s75, 6356992
    s_add_u32 s76, s69, 3
    v_mov_b32 v22, s76
    buffer_store_dword v22, v21, s[4:7], s75 offen sc1
l_sg44:
    s_mov_b64 exec, -1
    s_cmp_eq_u32 s2, 0
    s_cbranch_scc0 l_w3e43
    v_mov_b32 v20, s69
    v_mov_b32 v21, 0
    s_mov_b32 s75, 6406144
    s_mov_b64 exec, 1
    buffer_store_dword v20, v21, s[4:7], s75 offen sc1
    s_mov_b64 exec, -1
l_w3e43:
l_w342:
    s_add_u32 m0, s45, 0
    s_add_u32 s53, s46, 0
    buffer_load_dwordx4 v158, s[16:19], s53 offen lds
    s_add_u32 m0, s45, 1024
    s_add_u32 s53, s46, 8192
    buffer_load_dwordx4 v158, s[16:19], s53 offen lds
    s_add_u32 m0, s45, 2048
    s_add_u32 s53, s46, 16384
    buffer_load_dwordx4 v158, s[16:19], s53 offen lds
    s_add_u32 m0, s45, 3072
    s_add_u32 s53, s46, 24576
    buffer_load_dwordx4 v158, s[16:19], s53 offen lds
    s_add_u32 m0, s45, 4096
    s_add_u32 s53, s46, 32768
    buffer_load_dwordx4 v158, s[16:19], s53 offen lds
    s_add_u32 m0, s45, 5120
    s_add_u32 s53, s46, 40960
    buffer_load_dwordx4 v158, s[16:19], s53 offen lds
    s_add_u32 m0, s45, 6144
    s_add_u32 s53, s46, 49152
    buffer_load_dwordx4 v158, s[16:19], s53 offen lds
    s_add_u32 m0, s45, 7168
    s_add_u32 s53, s46, 57344
    buffer_load_dwordx4 v158, s[16:19], s53 offen lds
    s_add_u32 m0, s45, 8192
    s_add_u32 s53, s46, 65536
    buffer_load_dwordx4 v158, s[16:19], s53 offen lds
    s_add_u32 m0, s45, 9216
    s_add_u32 s53, s46, 73728
    buffer_load_dwordx4 v158, s[16:19], s53 offen lds
    s_add_u32 m0, s45, 10240
    s_add_u32 s53, s46, 81920
    buffer_load_dwordx4 v158, s[16:19], s53 offen lds
    s_add_u32 m0, s45, 11264
    s_add_u32 s53, s46, 90112
    buffer_load_dwordx4 v158, s[16:19], s53 offen lds
    s_cmp_eq_u32 s3, 0
    s_cbranch_scc0 l_w3p45
    s_lshr_b32 s75, s67, 4
    s_lshl_b32 s76, s66, 1
    s_add_u32 s75, s75, s76
    s_lshr_b32 s76, s75, 3
    s_and_b32 s75, s75, 7
    s_lshl_b32 s76, s76, 12
    s_lshl_b32 s75, s75, 9
    s_add_u32 s48, s75, s76
    s_add_u32 s48, s48, 6356992
    v_bfe_u32 v21, v2, 2, 2
    v_lshlrev_b32 v21, 13, v21
    v_and_b32 v22, 3, v2
    v_lshl_add_u32 v21, v22, 7, v21
    s_add_u32 s76, s69, 3
    s_mov_b32 s77, 0
l_vl46:
    buffer_load_dword v20, v21, s[4:7], s48 offen sc1
    s_waitcnt vmcnt(0)
    v_cmp_ne_u32 vcc, s76, v20
    s_nop 1
    s_cmp_eq_u64 vcc, 0
    s_cbranch_scc1 l_vd47
    s_add_u32 s77, s77, 1
    s_cmp_lt_u32 s77, 20000
    s_cbranch_scc1 l_vl46
l_vd47:
l_w3p45:
    s_waitcnt vmcnt(0)
    s_barrier
    s_add_u32 s53, s41, 24576
    buffer_load_dwordx4 v[64:67], v3, s[4:7], s53 offen offset:0 sc1
    buffer_load_dwordx4 v[68:71], v3, s[4:7], s53 offen offset:1024 sc1
    buffer_load_dwordx4 v[72:75], v3, s[4:7], s53 offen offset:2048 sc1
    buffer_load_dwordx4 v[76:79], v3, s[4:7], s53 offen offset:3072 sc1
    s_add_u32 s53, s41, 0
    buffer_load_dwordx4 v[80:83], v3, s[4:7], s53 offen offset:0 sc1
    buffer_load_dwordx4 v[84:87], v3, s[4:7], s53 offen offset:1024 sc1
    ds_read_b64_tr_b16 v[48:49], v10 offset:10240
    ds_read_b64_tr_b16 v[50:51], v10 offset:10752
    ds_read_b64_tr_b16 v[52:53], v11 offset:10240
    ds_read_b64_tr_b16 v[54:55], v11 offset:10752
    ds_read_b64_tr_b16 v[56:57], v10 offset:12288
    ds_read_b64_tr_b16 v[58:59], v10 offset:12800
    ds_read_b64_tr_b16 v[60:61], v11 offset:12288
    ds_read_b64_tr_b16 v[62:63], v11 offset:12800
    s_waitcnt vmcnt(5)
    s_waitcnt lgkmcnt(4)
    v_mfma_f32_32x32x16_bf16 v[16:31], v[48:51], v[64:67], 0
    v_mfma_f32_32x32x16_bf16 v[32:47], v[52:55], v[64:67], 0
    s_add_u32 s53, s41, 0
    buffer_load_dwordx4 v[64:67], v3, s[4:7], s53 offen offset:2048 sc1
    ds_read_b64_tr_b16 v[48:49], v12 offset:0
    ds_read_b64_tr_b16 v[50:51], v12 offset:512
    ds_read_b64_tr_b16 v[52:53], v13 offset:0
    ds_read_b64_tr_b16 v[54:55], v13 offset:512
    s_waitcnt vmcnt(5)
    s_waitcnt lgkmcnt(4)
    v_mfma_f32_32x32x16_bf16 v[16:31], v[56:59], v[68:71], v[16:31]
    v_mfma_f32_32x32x16_bf16 v[32:47], v[60:63], v[68:71], v[32:47]
    s_add_u32 s53, s41, 0
    buffer_load_dwordx4 v[68:71], v3, s[4:7], s53 offen offset:3072 sc1
    ds_read_b64_tr_b16 v[56:57], v12 offset:2048
    ds_read_b64_tr_b16 v[58:59], v12 offset:2560
    ds_read_b64_tr_b16 v[60:61], v13 offset:2048
    ds_read_b64_tr_b16 v[62:63], v13 offset:2560
    s_waitcnt vmcnt(5)
    s_waitcnt lgkmcnt(4)
    v_mfma_f32_32x32x16_bf16 v[16:31], v[48:51], v[72:75], v[16:31]
    v_mfma_f32_32x32x16_bf16 v[32:47], v[52:55], v[72:75], v[32:47]
    s_add_u32 s53, s41, 4096
    buffer_load_dwordx4 v[72:75], v3, s[4:7], s53 offen offset:0 sc1
    ds_read_b64_tr_b16 v[48:49], v8 offset:0
    ds_read_b64_tr_b16 v[50:51], v8 offset:512
    ds_read_b64_tr_b16 v[52:53], v9 offset:0
    ds_read_b64_tr_b16 v[54:55], v9 offset:512
    s_waitcnt vmcnt(5)
    s_waitcnt lgkmcnt(4)
    v_mfma_f32_32x32x16_bf16 v[16:31], v[56:59], v[76:79], v[16:31]
    v_mfma_f32_32x32x16_bf16 v[32:47], v[60:63], v[76:79], v[32:47]
    s_add_u32 s53, s41, 4096
    buffer_load_dwordx4 v[76:79], v3, s[4:7], s53 offen offset:1024 sc1
    ds_read_b64_tr_b16 v[56:57], v8 offset:2048
    ds_read_b64_tr_b16 v[58:59], v8 offset:2560
    ds_read_b64_tr_b16 v[60:61], v9 offset:2048
    ds_read_b64_tr_b16 v[62:63], v9 offset:2560
    s_waitcnt vmcnt(5)
    s_waitcnt lgkmcnt(4)
    v_mfma_f32_32x32x16_bf16 v[16:31], v[48:51], v[80:83], v[16:31]
    v_mfma_f32_32x32x16_bf16 v[32:47], v[52:55], v[80:83], v[32:47]
    s_add_u32 s53, s41, 4096
    buffer_load_dwordx4 v[80:83], v3, s[4:7], s53 offen offset:2048 sc1
    ds_read_b64_tr_b16 v[48:49], v8 offset:4096
    ds_read_b64_tr_b16 v[50:51], v8 offset:4608
    ds_read_b64_tr_b16 v[52:53], v9 offset:4096
    ds_read_b64_tr_b16 v[54:55], v9 offset:4608
    s_waitcnt vmcnt(5)
    s_waitcnt lgkmcnt(4)
    v_mfma_f32_32x32x16_bf16 v[16:31], v[56:59], v[84:87], v[16:31]
    v_mfma_f32_32x32x16_bf16 v[32:47], v[60:63], v[84:87], v[32:47]
    s_add_u32 s53, s41, 4096
    buffer_load_dwordx4 v[84:87], v3, s[4:7], s53 offen offset:3072 sc1
    ds_read_b64_tr_b16 v[56:57], v8 offset:6144
    ds_read_b64_tr_b16 v[58:59], v8 offset:6656
    ds_read_b64_tr_b16 v[60:61], v9 offset:6144
    ds_read_b64_tr_b16 v[62:63], v9 offset:6656
    s_waitcnt vmcnt(5)
    s_waitcnt lgkmcnt(4)
    v_mfma_f32_32x32x16_bf16 v[16:31], v[48:51], v[64:67], v[16:31]
    v_mfma_f32_32x32x16_bf16 v[32:47], v[52:55], v[64:67], v[32:47]
    s_add_u32 s53, s41, 8192
    buffer_load_dwordx4 v[64:67], v3, s[4:7], s53 offen offset:0 sc1
    ds_read_b64_tr_b16 v[48:49], v8 offset:8192
    ds_read_b64_tr_b16 v[50:51], v8 offset:8704
    ds_read_b64_tr_b16 v[52:53], v9 offset:8192
    ds_read_b64_tr_b16 v[54:55], v9 offset:8704
    s_waitcnt vmcnt(5)
    s_waitcnt lgkmcnt(4)
    v_mfma_f32_32x32x16_bf16 v[16:31], v[56:59], v[68:71], v[16:31]
    v_mfma_f32_32x32x16_bf16 v[32:47], v[60:63], v[68:71], v[32:47]
    s_add_u32 s53, s41, 8192
    buffer_load_dwordx4 v[68:71], v3, s[4:7], s53 offen offset:1024 sc1
    ds_read_b64_tr_b16 v[56:57], v8 offset:10240
    ds_read_b64_tr_b16 v[58:59], v8 offset:10752
    ds_read_b64_tr_b16 v[60:61], v9 offset:10240
    ds_read_b64_tr_b16 v[62:63], v9 offset:10752
    s_waitcnt vmcnt(5)
    s_waitcnt lgkmcnt(4)
    v_mfma_f32_32x32x16_bf16 v[16:31], v[48:51], v[72:75], v[16:31]
    v_mfma_f32_32x32x16_bf16 v[32:47], v[52:55], v[72:75], v[32:47]
    s_add_u32 s53, s41, 8192
    buffer_load_dwordx4 v[72:75], v3, s[4:7], s53 offen offset:2048 sc1
    ds_read_b64_tr_b16 v[48:49], v8 offset:12288
    ds_read_b64_tr_b16 v[50:51], v8 offset:12800
    ds_read_b64_tr_b16 v[52:53], v9 offset:12288
    ds_read_b64_tr_b16 v[54:55], v9 offset:12800
    s_waitcnt vmcnt(5)
    s_waitcnt lgkmcnt(4)
    v_mfma_f32_32x32x16_bf16 v[16:31], v[56:59], v[76:79], v[16:31]
    v_mfma_f32_32x32x16_bf16 v[32:47], v[60:63], v[76:79], v[32:47]
    s_add_u32 s53, s41, 8192
    buffer_load_dwordx4 v[76:79], v3, s[4:7], s53 offen offset:3072 sc1
    ds_read_b64_tr_b16 v[56:57], v10 offset:0
    ds_read_b64_tr_b16 v[58:59], v10 offset:512
    ds_read_b64_tr_b16 v[60:61], v11 offset:0
    ds_read_b64_tr_b16 v[62:63], v11 offset:512
    s_waitcnt vmcnt(5)
    s_waitcnt lgkmcnt(4)
    v_mfma_f32_32x32x16_bf16 v[16:31], v[48:51], v[80:83], v[16:31]
    v_mfma_f32_32x32x16_bf16 v[32:47], v[52:55], v[80:83], v[32:47]
    s_add_u32 s53, s41, 12288
    buffer_load_dwordx4 v[80:83], v3, s[4:7], s53 offen offset:0 sc1
    ds_read_b64_tr_b16 v[48:49], v10 offset:2048
    ds_read_b64_tr_b16 v[50:51], v10 offset:2560
    ds_read_b64_tr_b16 v[52:53], v11 offset:2048
    ds_read_b64_tr_b16 v[54:55], v11 offset:2560
    s_waitcnt vmcnt(5)
    s_waitcnt lgkmcnt(4)
    v_mfma_f32_32x32x16_bf16 v[16:31], v[56:59], v[84:87], v[16:31]
    v_mfma_f32_32x32x16_bf16 v[32:47], v[60:63], v[84:87], v[32:47]
    s_add_u32 s53, s41, 12288
    buffer_load_dwordx4 v[84:87], v3, s[4:7], s53 offen offset:1024 sc1
    ds_read_b64_tr_b16 v[56:57], v10 offset:4096
    ds_read_b64_tr_b16 v[58:59], v10 offset:4608
    ds_read_b64_tr_b16 v[60:61], v11 offset:4096
    ds_read_b64_tr_b16 v[62:63], v11 offset:4608
    s_waitcnt vmcnt(5)
    s_waitcnt lgkmcnt(4)
    v_mfma_f32_32x32x16_bf16 v[16:31], v[48:51], v[64:67], v[16:31]
    v_mfma_f32_32x32x16_bf16 v[32:47], v[52:55], v[64:67], v[32:47]
    s_add_u32 s53, s41, 12288
    buffer_load_dwordx4 v[64:67], v3, s[4:7], s53 offen offset:2048 sc1
    ds_read_b64_tr_b16 v[48:49], v10 offset:6144
    ds_read_b64_tr_b16 v[50:51], v10 offset:6656
    ds_read_b64_tr_b16 v[52:53], v11 offset:6144
    ds_read_b64_tr_b16 v[54:55], v11 offset:6656
    s_waitcnt vmcnt(5)
    s_waitcnt lgkmcnt(4)
    v_mfma_f32_32x32x16_bf16 v[16:31], v[56:59], v[68:71], v[16:31]
    v_mfma_f32_32x32x16_bf16 v[32:47], v[60:63], v[68:71], v[32:47]
    s_add_u32 s53, s41, 12288
    buffer_load_dwordx4 v[68:71], v3, s[4:7], s53 offen offset:3072 sc1
    ds_read_b64_tr_b16 v[56:57], v10 offset:8192
    ds_read_b64_tr_b16 v[58:59], v10 offset:8704
    ds_read_b64_tr_b16 v[60:61], v11 offset:8192
    ds_read_b64_tr_b16 v[62:63], v11 offset:8704
    s_waitcnt vmcnt(5)
    s_waitcnt lgkmcnt(4)
    v_mfma_f32_32x32x16_bf16 v[16:31], v[48:51], v[72:75], v[16:31]
    v_mfma_f32_32x32x16_bf16 v[32:47], v[52:55], v[72:75], v[32:47]
    s_add_u32 s53, s41, 16384
    buffer_load_dwordx4 v[72:75], v3, s[4:7], s53 offen offset:0 sc1
    s_waitcnt vmcnt(5)
    s_waitcnt lgkmcnt(0)
    v_mfma_f32_32x32x16_bf16 v[16:31], v[56:59], v[76:79], v[16:31]
    v_mfma_f32_32x32x16_bf16 v[32:47], v[60:63], v[76:79], v[32:47]
    s_add_u32 s53, s41, 16384
    buffer_load_dwordx4 v[76:79], v3, s[4:7], s53 offen offset:1024 sc1
    ds_read_b64_tr_b16 v[56:57], v4 offset:0
    ds_read_b64_tr_b16 v[58:59], v4 offset:256
    s_waitcnt vmcnt(5)
    v_mfma_f32_32x32x16_bf16 v[16:31], a[0:3], v[80:83], v[16:31]
    v_mfma_f32_32x32x16_bf16 v[32:47], a[4:7], v[80:83], v[32:47]
    s_add_u32 s53, s41, 16384
    buffer_load_dwordx4 v[80:83], v3, s[4:7], s53 offen offset:2048 sc1
    s_waitcnt vmcnt(5)
    v_mfma_f32_32x32x16_bf16 v[16:31], a[8:11], v[84:87], v[16:31]
    v_mfma_f32_32x32x16_bf16 v[32:47], a[12:15], v[84:87], v[32:47]
    s_add_u32 s53, s41, 16384
    buffer_load_dwordx4 v[84:87], v3, s[4:7], s53 offen offset:3072 sc1
    s_waitcnt vmcnt(5)
    s_barrier
    v_mfma_f32_32x32x16_bf16 v[16:31], a[16:19], v[64:67], v[16:31]
    v_mfma_f32_32x32x16_bf16 v[32:47], a[20:23], v[64:67], v[32:47]
    s_add_u32 s53, s41, 20480
    buffer_load_dwordx4 v[64:67], v3, s[4:7], s53 offen offset:0 sc1
    s_waitcnt vmcnt(5)
    v_mfma_f32_32x32x16_bf16 v[16:31], a[24:27], v[68:71], v[16:31]
    v_mfma_f32_32x32x16_bf16 v[32:47], a[28:31], v[68:71], v[32:47]
    s_add_u32 s53, s41, 20480
    buffer_load_dwordx4 v[68:71], v3, s[4:7], s53 offen offset:1024 sc1
    s_waitcnt vmcnt(5)
    v_mfma_f32_32x32x16_bf16 v[16:31], a[32:35], v[72:75], v[16:31]
    v_mfma_f32_32x32x16_bf16 v[32:47], a[36:39], v[72:75], v[32:47]
    s_waitcnt lgkmcnt(0)
    v_lshlrev_b32 v48, 16, v56
    v_and_b32 v49, s72, v56
    v_lshlrev_b32 v50, 16, v57
    v_and_b32 v51, s72, v57
    v_lshlrev_b32 v52, 16, v58
    v_and_b32 v53, s72, v58
    v_lshlrev_b32 v54, 16, v59
    v_and_b32 v55, s72, v59
    s_add_u32 s53, s41, 20480
    buffer_load_dwordx4 v[72:75], v3, s[4:7], s53 offen offset:2048 sc1
    s_waitcnt vmcnt(5)
    v_mfma_f32_32x32x16_bf16 v[16:31], a[40:43], v[76:79], v[16:31]
    v_mfma_f32_32x32x16_bf16 v[32:47], a[44:47], v[76:79], v[32:47]
    s_add_u32 s53, s41, 20480
    buffer_load_dwordx4 v[76:79], v3, s[4:7], s53 offen offset:3072 sc1
    s_waitcnt vmcnt(5)
    v_mfma_f32_32x32x16_bf16 v[16:31], a[48:51], v[80:83], v[16:31]
    v_mfma_f32_32x32x16_bf16 v[32:47], a[52:55], v[80:83], v[32:47]
    s_waitcnt vmcnt(4)
    v_mfma_f32_32x32x16_bf16 v[16:31], a[56:59], v[84:87], v[16:31]
    v_mfma_f32_32x32x16_bf16 v[32:47], a[60:63], v[84:87], v[32:47]
    s_waitcnt vmcnt(3)
    v_mfma_f32_32x32x16_bf16 v[16:31], a[64:67], v[64:67], v[16:31]
    v_mfma_f32_32x32x16_bf16 v[32:47], a[68:71], v[64:67], v[32:47]
    s_waitcnt vmcnt(2)
    v_mfma_f32_32x32x16_bf16 v[16:31], a[72:75], v[68:71], v[16:31]
    v_mfma_f32_32x32x16_bf16 v[32:47], a[76:79], v[68:71], v[32:47]
    s_waitcnt vmcnt(1)
    v_mfma_f32_32x32x16_bf16 v[16:31], a[80:83], v[72:75], v[16:31]
    v_mfma_f32_32x32x16_bf16 v[32:47], a[84:87], v[72:75], v[32:47]
    s_waitcnt vmcnt(0)
    v_mfma_f32_32x32x16_bf16 v[16:31], a[88:91], v[76:79], v[16:31]
    v_mfma_f32_32x32x16_bf16 v[32:47], a[92:95], v[76:79], v[32:47]
    s_nop 10
    ds_write_b128 v14, v[16:19] offset:0
    ds_write_b128 v14, v[20:23] offset:1024
    ds_write_b128 v14, v[24:27] offset:8192
    ds_write_b128 v14, v[28:31] offset:9216
    ds_write_b128 v14, v[32:35] offset:16384
    ds_write_b128 v14, v[36:39] offset:17408
    ds_write_b128 v14, v[40:43] offset:24576
    ds_write_b128 v14, v[44:47] offset:25600
    s_waitcnt lgkmcnt(0)
    s_barrier
    ds_read_b128 v[96:99], v15 offset:0
    ds_read_b128 v[100:103], v15 offset:1024
    ds_read_b128 v[104:107], v15 offset:2048
    ds_read_b128 v[108:111], v15 offset:3072
    ds_read_b128 v[112:115], v15 offset:4096
    ds_read_b128 v[116:119], v15 offset:5120
    ds_read_b128 v[120:123], v15 offset:6144
    ds_read_b128 v[124:127], v15 offset:7168
    s_waitcnt lgkmcnt(6)
    v_pk_add_f32 v[48:49], v[48:49], v[96:97]
    v_pk_add_f32 v[50:51], v[50:51], v[98:99]
    v_pk_add_f32 v[52:53], v[52:53], v[100:101]
    v_pk_add_f32 v[54:55], v[54:55], v[102:103]
    s_waitcnt lgkmcnt(4)
    v_pk_add_f32 v[48:49], v[48:49], v[104:105]
    v_pk_add_f32 v[50:51], v[50:51], v[106:107]
    v_pk_add_f32 v[52:53], v[52:53], v[108:109]
    v_pk_add_f32 v[54:55], v[54:55], v[110:111]
    s_waitcnt lgkmcnt(2)
    v_pk_add_f32 v[48:49], v[48:49], v[112:113]
    v_pk_add_f32 v[50:51], v[50:51], v[114:115]
    v_pk_add_f32 v[52:53], v[52:53], v[116:117]
    v_pk_add_f32 v[54:55], v[54:55], v[118:119]
    s_waitcnt lgkmcnt(0)
    v_pk_add_f32 v[48:49], v[48:49], v[120:121]
    v_pk_add_f32 v[50:51], v[50:51], v[122:123]
    v_pk_add_f32 v[52:53], v[52:53], v[124:125]
    v_pk_add_f32 v[54:55], v[54:55], v[126:127]
    v_cvt_pk_bf16_f32 v56, v48, v49
    v_cvt_pk_bf16_f32 v57, v50, v51
    v_cvt_pk_bf16_f32 v58, v52, v53
    v_cvt_pk_bf16_f32 v59, v54, v55
    buffer_store_dwordx4 v[56:59], v5, s[20:23], s43 offen
    s_endpgm
k_hi:
    s_load_dwordx16 s[48:63], s[0:1], 32
    s_load_dwordx2 s[64:65], s[0:1], 96
    s_getreg_b32 s68, hwreg(HW_REG_XCC_ID, 0, 4)
    v_lshlrev_b32 v3, 4, v2
    s_and_b32 s68, s68, 7
    s_add_u32 s68, s68, 1
    s_mov_b32 s72, 0xffff0000
    s_mov_b32 s70, 0
    s_and_b32 s73, s3, 3
    s_lshl_b32 s75, s66, 6
    s_lshl_b32 s76, s67, 1
    s_add_u32 s75, s75, s76
    s_and_b32 s76, s3, 1
    s_add_u32 s75, s75, s76
    s_lshl_b32 s74, s75, 12
    s_getpc_b64 s[76:77]
k_pc:
    s_sub_u32 s76, s76, k_pc-sequential_preLN__ssm_conv_h3__glu_gated_swiglu__prompt_kernel
    s_subb_u32 s77, s77, 0
    s_lshl_b32 s75, s67, 1
    s_add_u32 s75, s75, s73
    s_mul_i32 s75, s75, 640
    s_sub_u32 s75, s75, 1280
    s_cmp_eq_u32 s73, 0
    s_cselect_b32 s75, 256, s75
    s_cmp_eq_u32 s73, 1
    s_cselect_b32 s75, k_pc-sequential_preLN__ssm_conv_h3__glu_gated_swiglu__prompt_kernel, s75
    v_add_u32 v7, s75, v3
    v_min_u32 v7, k_end-sequential_preLN__ssm_conv_h3__glu_gated_swiglu__prompt_kernel-16, v7
    global_load_dwordx4 v[140:143], v7, s[76:77]
    s_lshl_b32 s75, s2, 2
    s_add_u32 s75, s75, s73
    s_mul_i32 s75, s75, 14
    v_min_u32 v149, 13, v2
    v_add_u32 v149, s75, v149
    v_lshlrev_b32 v149, 7, v149
    s_lshl_b32 s76, s2, 13
    s_lshl_b32 s77, s73, 11
    s_add_u32 s76, s76, s77
    v_add_u32 v11, s76, v3
    s_waitcnt lgkmcnt(0)
    s_mov_b32 s75, 6406144
    s_load_dword s69, s[64:65], s75
    s_mov_b32 s28, s24
    s_and_b32 s29, s25, 0xffff
    s_mov_b32 s30, 0x200000
    s_mov_b32 s31, 0x20000
    buffer_load_dwordx4 v[68:71], v11, s[28:31], 0 offen offset:0 nt
    buffer_load_dwordx4 v[72:75], v11, s[28:31], 0 offen offset:1024 nt
    s_mov_b32 s24, s48
    s_and_b32 s25, s49, 0xffff
    s_mov_b32 s26, 0x200000
    s_mov_b32 s27, 0x20000
    s_mov_b32 s4, s64
    s_and_b32 s5, s65, 0xffff
    s_mov_b32 s6, 0x1000000
    s_mov_b32 s7, 0x20000
    s_mov_b32 s8, s62
    s_and_b32 s9, s63, 0xffff
    s_mov_b32 s10, 0x100
    s_mov_b32 s11, 0x20000
    s_mov_b32 s16, s58
    s_and_b32 s17, s59, 0xffff
    s_mov_b32 s18, 0x1c0000
    s_mov_b32 s19, 0x20000
    s_mov_b32 s20, s60
    s_and_b32 s21, s61, 0xffff
    s_mov_b32 s22, 0x200000
    s_mov_b32 s23, 0x20000
    s_cmp_ge_u32 s73, 2
    s_cselect_b32 s75, s56, s54
    s_cselect_b32 s76, s57, s55
    s_mov_b32 s12, s75
    s_and_b32 s13, s76, 0xffff
    s_mov_b32 s14, 0x1c0000
    s_mov_b32 s15, 0x20000
    s_lshr_b32 s44, s73, 1
    s_and_b32 s45, s73, 1
    s_and_b32 s46, s74, 0xffffe000
    s_lshl_b32 s47, s44, 12
    s_add_u32 s46, s46, s47
    s_mul_i32 s47, s44, 16640
    s_add_u32 s47, s47, 106496
    s_lshl_b32 s52, s45, 11
    s_add_u32 s53, s52, s46
    s_add_u32 s52, s52, s47
    v_add_u32 v7, s52, v3
    s_mul_i32 s52, s45, 8320
    s_add_u32 s47, s47, s52
    s_barrier
    buffer_load_dwordx4 v[16:19], v3, s[24:27], s53 offen offset:0 nt
    buffer_load_dwordx4 v[20:23], v3, s[24:27], s53 offen offset:4 nt
    buffer_load_dword v24, v3, s[24:27], s53 offen offset:20 nt
    buffer_load_dwordx4 v[28:31], v3, s[24:27], s53 offen offset:1024 nt
    buffer_load_dwordx4 v[32:35], v3, s[24:27], s53 offen offset:1028 nt
    buffer_load_dword v36, v3, s[24:27], s53 offen offset:1044 nt
    s_lshl_b32 s75, s67, 7
    s_sub_u32 s76, 3968, s75
    s_add_u32 s75, s75, 2097152
    s_cmp_eq_u32 s44, 0
    s_cselect_b32 s75, s76, s75
    s_lshl_b32 s76, s66, 1
    s_add_u32 s76, s76, s45
    s_lshl_b32 s76, s76, 17
    s_add_u32 s75, s75, s76
    v_and_b32 v5, 31, v2
    v_lshlrev_b32 v5, 12, v5
    buffer_load_dword v151, v5, s[4:7], s75 offen nt
    s_load_dwordx2 s[54:55], s[48:49], s46
    v_mov_b32 v8, 0
    v_mov_b32 v9, 0
    v_mov_b32 v10, 0
    v_mov_b32 v11, 0
    v_mov_b32 v12, 0
    v_mov_b32 v13, 0
    v_mov_b32 v14, 0
    v_mov_b32 v15, 0
    v_mov_b32 v40, s47
    s_waitcnt lgkmcnt(0)
    s_and_b32 s69, s69, -4
    s_add_u32 s69, s69, 4
    s_lshr_b32 s75, s69, 2
    s_mul_i32 s75, s75, 0x9e3779b1
    s_bfe_u32 s32, s75, 0x80000
    s_bfe_u32 s33, s75, 0x80008
    s_bfe_u32 s34, s75, 0x80010
    s_bfe_u32 s35, s75, 0x80018
    s_lshl_b32 s58, s54, 16
    s_lshr_b32 s59, s54, 16
    s_lshl_b32 s60, s55, 16
    s_or_b32 s59, s59, s60
    s_cmp_eq_u32 s45, 0
    s_cselect_b32 s54, 0, s54
    s_cselect_b32 s60, 0, s58
    s_cselect_b32 s59, s58, s59
    v_mov_b32 v15, s54
    v_mov_b32 v44, 0
    v_mov_b32 v45, 0
    v_mov_b32 v46, s60
    v_mov_b32 v47, s59
    s_mov_b64 exec, 1
    ds_write_b128 v40, v[8:11]
    ds_write_b128 v40, v[8:11] offset:4160
    ds_write_b128 v40, v[12:15] offset:16
    ds_write_b128 v40, v[44:47] offset:4176
    s_mov_b64 exec, -1
    s_waitcnt vmcnt(7)
    v_lshlrev_b32 v80, 16, v68
    v_and_b32 v81, s72, v68
    v_lshlrev_b32 v82, 16, v69
    v_and_b32 v83, s72, v69
    v_lshlrev_b32 v84, 16, v70
    v_and_b32 v85, s72, v70
    v_lshlrev_b32 v86, 16, v71
    v_and_b32 v87, s72, v71
    v_lshlrev_b32 v88, 16, v72
    v_and_b32 v89, s72, v72
    v_lshlrev_b32 v90, 16, v73
    v_and_b32 v91, s72, v73
    v_lshlrev_b32 v92, 16, v74
    v_and_b32 v93, s72, v74
    v_lshlrev_b32 v94, 16, v75
    v_and_b32 v95, s72, v75
    v_add_f32 v96, v80, v81
    v_add_f32 v97, v88, v89
    v_add_f32 v96, v96, v82
    v_add_f32 v97, v97, v90
    v_add_f32 v96, v96, v83
    v_add_f32 v97, v97, v91
    v_add_f32 v96, v96, v84
    v_add_f32 v97, v97, v92
    v_add_f32 v96, v96, v85
    v_add_f32 v97, v97, v93
    v_add_f32 v96, v96, v86
    v_add_f32 v97, v97, v94
    v_add_f32 v96, v96, v87
    v_add_f32 v97, v97, v95
    s_nop 0
    v_add_f32_dpp v96, v96, v96 quad_perm:[1,0,3,2] row_mask:0xf bank_mask:0xf
    v_add_f32_dpp v97, v97, v97 quad_perm:[1,0,3,2] row_mask:0xf bank_mask:0xf
    s_nop 0
    v_add_f32_dpp v96, v96, v96 quad_perm:[2,3,0,1] row_mask:0xf bank_mask:0xf
    v_add_f32_dpp v97, v97, v97 quad_perm:[2,3,0,1] row_mask:0xf bank_mask:0xf
    s_nop 0
    v_add_f32_dpp v96, v96, v96 row_half_mirror row_mask:0xf bank_mask:0xf
    v_add_f32_dpp v97, v97, v97 row_half_mirror row_mask:0xf bank_mask:0xf
    s_nop 0
    v_add_f32_dpp v96, v96, v96 row_mirror row_mask:0xf bank_mask:0xf
    v_add_f32_dpp v97, v97, v97 row_mirror row_mask:0xf bank_mask:0xf
    s_nop 0
    v_add_f32_dpp v96, v96, v96 row_bcast:15 row_mask:0xa bank_mask:0xf
    v_add_f32_dpp v97, v97, v97 row_bcast:15 row_mask:0xa bank_mask:0xf
    s_nop 0
    v_add_f32_dpp v96, v96, v96 row_bcast:31 row_mask:0xc bank_mask:0xf
    v_add_f32_dpp v97, v97, v97 row_bcast:31 row_mask:0xc bank_mask:0xf
    v_mul_f32 v96, 0x3b000000, v96
    v_mul_f32 v97, 0x3b000000, v97
    v_readlane_b32 s42, v96, 63
    v_readlane_b32 s43, v97, 63
    s_nop 0
    v_subrev_f32 v80, s42, v80
    v_subrev_f32 v88, s43, v88
    v_subrev_f32 v81, s42, v81
    v_subrev_f32 v89, s43, v89
    v_subrev_f32 v82, s42, v82
    v_subrev_f32 v90, s43, v90
    v_subrev_f32 v83, s42, v83
    v_subrev_f32 v91, s43, v91
    v_subrev_f32 v84, s42, v84
    v_subrev_f32 v92, s43, v92
    v_subrev_f32 v85, s42, v85
    v_subrev_f32 v93, s43, v93
    v_subrev_f32 v86, s42, v86
    v_subrev_f32 v94, s43, v94
    v_subrev_f32 v87, s42, v87
    v_subrev_f32 v95, s43, v95
    v_mul_f32 v98, v80, v80
    v_mul_f32 v99, v88, v88
    v_fmac_f32 v98, v81, v81
    v_fmac_f32 v99, v89, v89
    v_fmac_f32 v98, v82, v82
    v_fmac_f32 v99, v90, v90
    v_fmac_f32 v98, v83, v83
    v_fmac_f32 v99, v91, v91
    v_fmac_f32 v98, v84, v84
    v_fmac_f32 v99, v92, v92
    v_fmac_f32 v98, v85, v85
    v_fmac_f32 v99, v93, v93
    v_fmac_f32 v98, v86, v86
    v_fmac_f32 v99, v94, v94
    v_fmac_f32 v98, v87, v87
    v_fmac_f32 v99, v95, v95
    s_nop 0
    v_add_f32_dpp v98, v98, v98 quad_perm:[1,0,3,2] row_mask:0xf bank_mask:0xf
    v_add_f32_dpp v99, v99, v99 quad_perm:[1,0,3,2] row_mask:0xf bank_mask:0xf
    s_nop 0
    v_add_f32_dpp v98, v98, v98 quad_perm:[2,3,0,1] row_mask:0xf bank_mask:0xf
    v_add_f32_dpp v99, v99, v99 quad_perm:[2,3,0,1] row_mask:0xf bank_mask:0xf
    s_nop 0
    v_add_f32_dpp v98, v98, v98 row_half_mirror row_mask:0xf bank_mask:0xf
    v_add_f32_dpp v99, v99, v99 row_half_mirror row_mask:0xf bank_mask:0xf
    s_nop 0
    v_add_f32_dpp v98, v98, v98 row_mirror row_mask:0xf bank_mask:0xf
    v_add_f32_dpp v99, v99, v99 row_mirror row_mask:0xf bank_mask:0xf
    s_nop 0
    v_add_f32_dpp v98, v98, v98 row_bcast:15 row_mask:0xa bank_mask:0xf
    v_add_f32_dpp v99, v99, v99 row_bcast:15 row_mask:0xa bank_mask:0xf
    s_nop 0
    v_add_f32_dpp v98, v98, v98 row_bcast:31 row_mask:0xc bank_mask:0xf
    v_add_f32_dpp v99, v99, v99 row_bcast:31 row_mask:0xc bank_mask:0xf
    s_mov_b32 s41, 0x3b000000
    v_mov_b32 v104, 0x3727c5ac
    v_fma_f32 v98, v98, s41, v104
    v_fma_f32 v99, v99, s41, v104
    v_rsq_f32 v100, v98
    v_rsq_f32 v102, v99
    v_mul_f32 v101, v100, -v96
    v_mul_f32 v103, v102, -v97
    v_mov_b32 v104, 0xffffff00
    v_and_or_b32 v100, v100, v104, s32
    v_and_or_b32 v101, v101, v104, s33
    v_and_or_b32 v102, v102, v104, s34
    v_and_or_b32 v103, v103, v104, s35
    s_lshl_b32 s75, s2, 5
    s_lshl_b32 s76, s44, 4
    s_add_u32 s75, s75, s76
    s_lshl_b32 s76, s45, 13
    s_add_u32 s75, s75, s76
    s_add_u32 s75, s75, 6291456
    v_mov_b32 v104, 0
    s_mov_b32 exec_lo, 0
    s_mov_b32 exec_hi, 0x80000000
    buffer_store_dwordx4 v[100:103], v104, s[4:7], s75 offen sc1
    s_mov_b64 exec, -1
    s_waitcnt vmcnt(5)
    ds_write_b128 v7, v[16:19] offset:32
    ds_write_b128 v7, v[20:23] offset:8352
    v_alignbit_b32 v48, v20, v16, 16
    v_alignbit_b32 v52, v21, v20, 16
    v_alignbit_b32 v49, v21, v20, 16
    v_alignbit_b32 v53, v22, v21, 16
    v_alignbit_b32 v50, v22, v21, 16
    v_alignbit_b32 v54, v23, v22, 16
    v_alignbit_b32 v51, v23, v22, 16
    v_alignbit_b32 v55, v24, v23, 16
    ds_write_b128 v7, v[48:51] offset:4192
    ds_write_b128 v7, v[52:55] offset:12512
    s_waitcnt vmcnt(2)
    ds_write_b128 v7, v[28:31] offset:1056
    ds_write_b128 v7, v[32:35] offset:9376
    v_alignbit_b32 v56, v32, v28, 16
    v_alignbit_b32 v60, v33, v32, 16
    v_alignbit_b32 v57, v33, v32, 16
    v_alignbit_b32 v61, v34, v33, 16
    v_alignbit_b32 v58, v34, v33, 16
    v_alignbit_b32 v62, v35, v34, 16
    v_alignbit_b32 v59, v35, v34, 16
    v_alignbit_b32 v63, v36, v35, 16
    ds_write_b128 v7, v[56:59] offset:5216
    ds_write_b128 v7, v[60:63] offset:13536
    s_waitcnt lgkmcnt(0)
    v_mov_b32 v8, 159240
    v_mov_b32 v9, 1
    s_mov_b64 exec, 1
    ds_add_u32 v8, v9
    s_mov_b64 exec, -1
    v_and_b32 v6, 15, v2
    v_lshrrev_b32 v7, 4, v2
    v_add_u32 v8, 1, v6
    v_and_b32 v9, 3, v8
    v_mul_u32_u24 v9, 4160, v9
    v_and_b32 v8, 28, v8
    v_lshl_add_u32 v9, v8, 1, v9
    v_lshl_add_u32 v9, v7, 4, v9
    s_and_b32 s62, s3, 1
    s_lshr_b32 s63, s73, 1
    s_lshl_b32 s61, s63, 6
    s_add_u32 s61, s61, 128
    s_mul_i32 s75, s62, 16640
    s_add_u32 s75, s75, s61
    s_add_u32 s75, s75, 106496
    v_add_u32 v9, s75, v9
    s_mul_i32 s52, s62, 4608
    s_add_u32 s52, s52, 149632
    v_lshlrev_b32 v8, 4, v7
    v_lshlrev_b32 v10, 5, v6
    v_sub_u32 v8, v8, v10
    s_add_u32 s75, s52, s61
    s_add_u32 s75, s75, 480
    v_add_u32 v8, s75, v8
    s_mul_i32 s51, s62, 24576
    s_add_u32 s51, s51, 100480
    v_lshrrev_b32 v14, 2, v6
    v_lshrrev_b32 v15, 1, v7
    v_lshl_add_u32 v14, v15, 3, v14
    v_and_b32 v15, 1, v6
    v_bfe_u32 v152, v6, 1, 1
    v_lshl_add_u32 v15, v15, 1, v152
    v_lshlrev_b32 v15, 3, v15
    v_and_b32 v152, 1, v7
    v_lshl_add_u32 v15, v152, 5, v15
    v_lshrrev_b32 v152, 3, v6
    v_lshl_add_u32 v15, v152, 6, v15
    v_lshl_add_u32 v152, v14, 7, v15
    s_lshr_b32 s40, s66, 1
    s_lshl_b32 s40, s40, 2
    s_and_b32 s41, s67, 3
    s_add_u32 s40, s40, s41
    s_and_b32 s41, s66, 1
    s_lshl_b32 s41, s41, 3
    s_lshr_b32 s47, s67, 2
    s_add_u32 s41, s41, s47
    s_lshl_b32 s42, s40, 3
    s_mul_i32 s42, s42, 896
    s_add_u32 s42, s42, 6455296
    s_and_b32 s75, s73, 1
    s_mul_i32 s76, s75, 448
    s_mul_i32 s77, s40, 224
    s_movk_i32 s44, 4682
    v_add_u32 v116, s76, v2
    v_mul_u32_u24 v117, s44, v116
    v_lshrrev_b32 v117, 16, v117
    v_mul_u32_u24 v118, 14, v117
    v_sub_u32 v118, v116, v118
    v_mul_u32_u24 v117, 3584, v117
    v_lshl_add_u32 v117, v118, 4, v117
    v_add_u32 v128, s77, v117
    v_add_u32 v116, s76, v2
    v_add_u32 v116, 64, v116
    v_mul_u32_u24 v117, s44, v116
    v_lshrrev_b32 v117, 16, v117
    v_mul_u32_u24 v118, 14, v117
    v_sub_u32 v118, v116, v118
    v_mul_u32_u24 v117, 3584, v117
    v_lshl_add_u32 v117, v118, 4, v117
    v_add_u32 v129, s77, v117
    v_add_u32 v116, s76, v2
    v_add_u32 v116, 128, v116
    v_mul_u32_u24 v117, s44, v116
    v_lshrrev_b32 v117, 16, v117
    v_mul_u32_u24 v118, 14, v117
    v_sub_u32 v118, v116, v118
    v_mul_u32_u24 v117, 3584, v117
    v_lshl_add_u32 v117, v118, 4, v117
    v_add_u32 v130, s77, v117
    v_add_u32 v116, s76, v2
    v_add_u32 v116, 192, v116
    v_mul_u32_u24 v117, s44, v116
    v_lshrrev_b32 v117, 16, v117
    v_mul_u32_u24 v118, 14, v117
    v_sub_u32 v118, v116, v118
    v_mul_u32_u24 v117, 3584, v117
    v_lshl_add_u32 v117, v118, 4, v117
    v_add_u32 v131, s77, v117
    v_add_u32 v116, s76, v2
    v_add_u32 v116, 256, v116
    v_mul_u32_u24 v117, s44, v116
    v_lshrrev_b32 v117, 16, v117
    v_mul_u32_u24 v118, 14, v117
    v_sub_u32 v118, v116, v118
    v_mul_u32_u24 v117, 3584, v117
    v_lshl_add_u32 v117, v118, 4, v117
    v_add_u32 v132, s77, v117
    v_add_u32 v116, s76, v2
    v_add_u32 v116, 320, v116
    v_mul_u32_u24 v117, s44, v116
    v_lshrrev_b32 v117, 16, v117
    v_mul_u32_u24 v118, 14, v117
    v_sub_u32 v118, v116, v118
    v_mul_u32_u24 v117, 3584, v117
    v_lshl_add_u32 v117, v118, 4, v117
    v_add_u32 v133, s77, v117
    v_add_u32 v116, s76, v2
    v_add_u32 v116, 384, v116
    v_mul_u32_u24 v117, s44, v116
    v_lshrrev_b32 v117, 16, v117
    v_mul_u32_u24 v118, 14, v117
    v_sub_u32 v118, v116, v118
    v_mul_u32_u24 v117, 3584, v117
    v_lshl_add_u32 v117, v118, 4, v117
    v_add_u32 v134, s77, v117
    s_lshr_b32 s76, s73, 1
    s_mul_i32 s45, s76, 57472
    s_mul_i32 s75, s75, 7168
    s_add_u32 s45, s45, s75
    s_mul_i32 s46, s73, 57344
    v_lshrrev_b32 v4, 3, v2
    v_and_b32 v116, 7, v2
    v_lshrrev_b32 v117, 2, v2
    v_and_b32 v117, 4, v117
    v_xor_b32 v116, v116, v117
    v_lshlrev_b32 v116, 4, v116
    v_lshl_add_u32 v4, v4, 10, v116
    s_and_b32 s75, s67, 7
    s_lshl_b32 s75, s75, 7
    v_add_u32 v4, s75, v4
    v_and_b32 v116, 1, v7
    v_lshrrev_b32 v117, 1, v7
    v_lshrrev_b32 v118, 2, v6
    v_lshl_add_u32 v119, v117, 3, v118
    v_and_b32 v120, 1, v6
    v_bfe_u32 v121, v6, 1, 1
    v_lshl_add_u32 v122, v120, 1, v121
    v_mul_u32_u24 v135, 224, v119
    v_lshl_add_u32 v135, v122, 3, v135
    v_mul_u32_u24 v122, 57472, v116
    v_add_u32 v135, v135, v122
    v_lshl_add_u32 v122, v116, 1, v121
    v_lshlrev_b32 v118, 2, v118
    s_lshl_b32 s75, s73, 2
    v_add_u32 v136, s75, v122
    v_xor_b32 v136, v136, v118
    v_lshlrev_b32 v136, 4, v136
    v_lshl_add_u32 v136, v120, 3, v136
    v_lshl_add_u32 v136, v119, 8, v136
    v_add_u32 v136, 114816, v136
    v_lshlrev_b32 v137, 6, v117
    v_add_u32 v137, 156288, v137
    v_mov_b32 v112, 159240
    s_mov_b32 s77, 0
h_rv1:
    ds_read_b32 v114, v112
    s_add_u32 s77, s77, 1
    s_waitcnt lgkmcnt(0)
    v_readfirstlane_b32 s76, v114
    s_cmp_ge_u32 s77, 160000
    s_cbranch_scc1 h_rd2
    s_cmp_lt_u32 s76, 4
    s_cbranch_scc1 h_rv1
h_rd2:
    ds_read_b64 v[16:17], v9 offset:0
    ds_read_b64 v[18:19], v9 offset:8
    ds_read_b64 v[20:21], v9 offset:256
    ds_read_b64 v[22:23], v9 offset:264
    ds_read_b64 v[24:25], v9 offset:512
    ds_read_b64 v[26:27], v9 offset:520
    ds_read_b64 v[28:29], v9 offset:768
    ds_read_b64 v[30:31], v9 offset:776
    ds_read_b64 v[32:33], v9 offset:1024
    ds_read_b64 v[34:35], v9 offset:1032
    ds_read_b64 v[36:37], v9 offset:1280
    ds_read_b64 v[38:39], v9 offset:1288
    ds_read_b64 v[40:41], v9 offset:1536
    ds_read_b64 v[42:43], v9 offset:1544
    ds_read_b64 v[44:45], v9 offset:1792
    ds_read_b64 v[46:47], v9 offset:1800
    ds_read_b64 v[48:49], v9 offset:2048
    ds_read_b64 v[50:51], v9 offset:2056
    ds_read_b64 v[52:53], v9 offset:2304
    ds_read_b64 v[54:55], v9 offset:2312
    ds_read_b64 v[56:57], v9 offset:2560
    ds_read_b64 v[58:59], v9 offset:2568
    ds_read_b64 v[60:61], v9 offset:2816
    ds_read_b64 v[62:63], v9 offset:2824
    ds_read_b64 v[64:65], v9 offset:3072
    ds_read_b64 v[66:67], v9 offset:3080
    ds_read_b64 v[68:69], v9 offset:3328
    ds_read_b64 v[70:71], v9 offset:3336
    ds_read_b64 v[72:73], v9 offset:3584
    ds_read_b64 v[74:75], v9 offset:3592
    ds_read_b64 v[76:77], v9 offset:3840
    ds_read_b64 v[78:79], v9 offset:3848
    s_waitcnt lgkmcnt(0)
    s_barrier
    s_barrier
    ds_read_b128 a[0:3], v8 offset:3840
    ds_read_b128 a[4:7], v8 offset:3584
    ds_read_b128 a[8:11], v8 offset:3328
    ds_read_b128 a[12:15], v8 offset:3072
    ds_read_b128 a[16:19], v8 offset:2816
    ds_read_b128 a[20:23], v8 offset:2560
    ds_read_b128 a[24:27], v8 offset:2304
    ds_read_b128 a[28:31], v8 offset:2048
    ds_read_b128 a[32:35], v8 offset:1792
    ds_read_b128 a[36:39], v8 offset:1536
    ds_read_b128 a[40:43], v8 offset:1280
    ds_read_b128 a[44:47], v8 offset:1024
    ds_read_b128 a[48:51], v8 offset:768
    ds_read_b128 a[52:55], v8 offset:512
    ds_read_b128 a[56:59], v8 offset:256
    ds_read_b128 a[60:63], v8 offset:0
    s_lshl_b32 s75, s63, 12
    s_add_u32 s75, s75, s51
    s_add_u32 s75, s75, 4096
    v_add_u32 v14, s75, v3
    v_add_u32 v15, 12288, v14
    s_waitcnt lgkmcnt(15)
    v_mfma_f32_16x16x32_bf16 v[108:111], v[76:79], a[0:3], 0
    v_mfma_f32_16x16x32_bf16 v[104:107], v[68:71], a[0:3], 0
    v_mfma_f32_16x16x32_bf16 v[100:103], v[60:63], a[0:3], 0
    v_mfma_f32_16x16x32_bf16 v[96:99], v[52:55], a[0:3], 0
    v_mfma_f32_16x16x32_bf16 v[92:95], v[44:47], a[0:3], 0
    v_mfma_f32_16x16x32_bf16 v[88:91], v[36:39], a[0:3], 0
    v_mfma_f32_16x16x32_bf16 v[84:87], v[28:31], a[0:3], 0
    v_mfma_f32_16x16x32_bf16 v[80:83], v[20:23], a[0:3], 0
    s_waitcnt lgkmcnt(14)
    v_mfma_f32_16x16x32_bf16 v[108:111], v[72:75], a[4:7], v[108:111]
    v_mfma_f32_16x16x32_bf16 v[104:107], v[64:67], a[4:7], v[104:107]
    v_mfma_f32_16x16x32_bf16 v[100:103], v[56:59], a[4:7], v[100:103]
    v_mfma_f32_16x16x32_bf16 v[96:99], v[48:51], a[4:7], v[96:99]
    s_add_u32 s54, s47, 0
    s_and_b32 s54, s54, 7
    s_mul_i32 s54, s54, 229376
    s_add_u32 m0, s45, 0
    s_nop 0
    buffer_load_dwordx4 v128, s[12:15], s54 offen lds
    v_mfma_f32_16x16x32_bf16 v[92:95], v[40:43], a[4:7], v[92:95]
    v_mfma_f32_16x16x32_bf16 v[88:91], v[32:35], a[4:7], v[88:91]
    v_mfma_f32_16x16x32_bf16 v[84:87], v[24:27], a[4:7], v[84:87]
    v_mfma_f32_16x16x32_bf16 v[80:83], v[16:19], a[4:7], v[80:83]
    s_add_u32 m0, s45, 1024
    s_nop 0
    buffer_load_dwordx4 v129, s[12:15], s54 offen lds
    s_waitcnt lgkmcnt(0)
    v_mfma_f32_16x16x32_bf16 v[108:111], v[68:71], a[8:11], v[108:111]
    v_mfma_f32_16x16x32_bf16 v[104:107], v[60:63], a[8:11], v[104:107]
    v_mfma_f32_16x16x32_bf16 v[100:103], v[52:55], a[8:11], v[100:103]
    v_mfma_f32_16x16x32_bf16 v[96:99], v[44:47], a[8:11], v[96:99]
    s_add_u32 m0, s45, 2048
    s_nop 0
    buffer_load_dwordx4 v130, s[12:15], s54 offen lds
    v_mfma_f32_16x16x32_bf16 v[92:95], v[36:39], a[8:11], v[92:95]
    v_mfma_f32_16x16x32_bf16 v[88:91], v[28:31], a[8:11], v[88:91]
    v_mfma_f32_16x16x32_bf16 v[84:87], v[20:23], a[8:11], v[84:87]
    v_mfma_f32_16x16x32_bf16 v[108:111], v[64:67], a[12:15], v[108:111]
    ds_write_b128 v14, v[80:83] offset:0
    s_add_u32 m0, s45, 3072
    s_nop 0
    buffer_load_dwordx4 v131, s[12:15], s54 offen lds
    v_mfma_f32_16x16x32_bf16 v[104:107], v[56:59], a[12:15], v[104:107]
    v_mfma_f32_16x16x32_bf16 v[100:103], v[48:51], a[12:15], v[100:103]
    v_mfma_f32_16x16x32_bf16 v[96:99], v[40:43], a[12:15], v[96:99]
    v_mfma_f32_16x16x32_bf16 v[92:95], v[32:35], a[12:15], v[92:95]
    s_add_u32 m0, s45, 4096
    s_nop 0
    buffer_load_dwordx4 v132, s[12:15], s54 offen lds
    v_mfma_f32_16x16x32_bf16 v[88:91], v[24:27], a[12:15], v[88:91]
    v_mfma_f32_16x16x32_bf16 v[84:87], v[16:19], a[12:15], v[84:87]
    v_mfma_f32_16x16x32_bf16 v[108:111], v[60:63], a[16:19], v[108:111]
    v_mfma_f32_16x16x32_bf16 v[104:107], v[52:55], a[16:19], v[104:107]
    s_add_u32 m0, s45, 5120
    s_nop 0
    buffer_load_dwordx4 v133, s[12:15], s54 offen lds
    v_mfma_f32_16x16x32_bf16 v[100:103], v[44:47], a[16:19], v[100:103]
    v_mfma_f32_16x16x32_bf16 v[96:99], v[36:39], a[16:19], v[96:99]
    v_mfma_f32_16x16x32_bf16 v[92:95], v[28:31], a[16:19], v[92:95]
    v_mfma_f32_16x16x32_bf16 v[88:91], v[20:23], a[16:19], v[88:91]
    s_add_u32 m0, s45, 6144
    s_nop 0
    buffer_load_dwordx4 v134, s[12:15], s54 offen lds
    v_mfma_f32_16x16x32_bf16 v[108:111], v[56:59], a[20:23], v[108:111]
    ds_write_b128 v14, v[84:87] offset:1024
    v_mfma_f32_16x16x32_bf16 v[104:107], v[48:51], a[20:23], v[104:107]
    v_mfma_f32_16x16x32_bf16 v[100:103], v[40:43], a[20:23], v[100:103]
    v_mfma_f32_16x16x32_bf16 v[96:99], v[32:35], a[20:23], v[96:99]
    s_nop 0
    s_nop 0
    buffer_load_dword v150, v149, s[16:19], 0 offen
    v_mfma_f32_16x16x32_bf16 v[92:95], v[24:27], a[20:23], v[92:95]
    v_mfma_f32_16x16x32_bf16 v[88:91], v[16:19], a[20:23], v[88:91]
    v_mfma_f32_16x16x32_bf16 v[108:111], v[52:55], a[24:27], v[108:111]
    v_mfma_f32_16x16x32_bf16 v[104:107], v[44:47], a[24:27], v[104:107]
    v_mfma_f32_16x16x32_bf16 v[100:103], v[36:39], a[24:27], v[100:103]
    v_mfma_f32_16x16x32_bf16 v[96:99], v[28:31], a[24:27], v[96:99]
    v_mfma_f32_16x16x32_bf16 v[92:95], v[20:23], a[24:27], v[92:95]
    v_mfma_f32_16x16x32_bf16 v[108:111], v[48:51], a[28:31], v[108:111]
    s_nop 1
    ds_write_b128 v14, v[88:91] offset:2048
    v_mfma_f32_16x16x32_bf16 v[104:107], v[40:43], a[28:31], v[104:107]
    v_mfma_f32_16x16x32_bf16 v[100:103], v[32:35], a[28:31], v[100:103]
    v_mfma_f32_16x16x32_bf16 v[96:99], v[24:27], a[28:31], v[96:99]
    v_mfma_f32_16x16x32_bf16 v[92:95], v[16:19], a[28:31], v[92:95]
    v_mfma_f32_16x16x32_bf16 v[108:111], v[44:47], a[32:35], v[108:111]
    v_mfma_f32_16x16x32_bf16 v[104:107], v[36:39], a[32:35], v[104:107]
    v_mfma_f32_16x16x32_bf16 v[100:103], v[28:31], a[32:35], v[100:103]
    v_mfma_f32_16x16x32_bf16 v[96:99], v[20:23], a[32:35], v[96:99]
    v_mfma_f32_16x16x32_bf16 v[108:111], v[40:43], a[36:39], v[108:111]
    s_nop 2
    ds_write_b128 v14, v[92:95] offset:3072
    v_mfma_f32_16x16x32_bf16 v[104:107], v[32:35], a[36:39], v[104:107]
    v_mfma_f32_16x16x32_bf16 v[100:103], v[24:27], a[36:39], v[100:103]
    v_mfma_f32_16x16x32_bf16 v[96:99], v[16:19], a[36:39], v[96:99]
    v_mfma_f32_16x16x32_bf16 v[108:111], v[36:39], a[40:43], v[108:111]
    v_mfma_f32_16x16x32_bf16 v[104:107], v[28:31], a[40:43], v[104:107]
    v_mfma_f32_16x16x32_bf16 v[100:103], v[20:23], a[40:43], v[100:103]
    v_mfma_f32_16x16x32_bf16 v[108:111], v[32:35], a[44:47], v[108:111]
    s_nop 3
    ds_write_b128 v15, v[96:99] offset:0
    v_mfma_f32_16x16x32_bf16 v[104:107], v[24:27], a[44:47], v[104:107]
    v_mfma_f32_16x16x32_bf16 v[100:103], v[16:19], a[44:47], v[100:103]
    v_mfma_f32_16x16x32_bf16 v[108:111], v[28:31], a[48:51], v[108:111]
    v_mfma_f32_16x16x32_bf16 v[104:107], v[20:23], a[48:51], v[104:107]
    v_mfma_f32_16x16x32_bf16 v[108:111], v[24:27], a[52:55], v[108:111]
    s_nop 4
    ds_write_b128 v15, v[100:103] offset:1024
    v_mfma_f32_16x16x32_bf16 v[104:107], v[16:19], a[52:55], v[104:107]
    v_mfma_f32_16x16x32_bf16 v[108:111], v[20:23], a[56:59], v[108:111]
    v_mfma_f32_16x16x32_bf16 v[108:111], v[16:19], a[60:63], v[108:111]
    s_nop 5
    ds_write_b128 v15, v[104:107] offset:2048
    s_nop 0
    ds_write_b128 v15, v[108:111] offset:3072
    s_waitcnt lgkmcnt(0)
    s_barrier
    s_barrier
    s_waitcnt vmcnt(1)
    v_mov_b32 v116, 159252
    v_mov_b32 v117, 1
    s_mov_b64 exec, 1
    ds_add_u32 v116, v117
    s_mov_b64 exec, -1
    v_mov_b32 v116, 159252
    s_mov_b32 s77, 0
h_rv3:
    ds_read_b32 v118, v116
    s_add_u32 s77, s77, 1
    s_waitcnt lgkmcnt(0)
    v_readfirstlane_b32 s76, v118
    s_cmp_ge_u32 s77, 160000
    s_cbranch_scc1 h_rd4
    s_cmp_lt_u32 s76, 4
    s_cbranch_scc1 h_rv3
h_rd4:
    s_sub_u32 s75, s3, 1
    s_lshl_b32 s76, s75, 5
    v_add_u32 v8, s76, v135
    ds_read_b64_tr_b16 v[80:81], v8 offset:0
    ds_read_b64_tr_b16 v[82:83], v8 offset:896
    ds_read_b64_tr_b16 v[84:85], v8 offset:3584
    ds_read_b64_tr_b16 v[86:87], v8 offset:4480
    ds_read_b64_tr_b16 v[88:89], v8 offset:7168
    ds_read_b64_tr_b16 v[90:91], v8 offset:8064
    ds_read_b64_tr_b16 v[92:93], v8 offset:10752
    ds_read_b64_tr_b16 v[94:95], v8 offset:11648
    v_mov_b32 v96, 0x3f803f80
    v_mov_b32 v97, 0x3f803f80
    v_mov_b32 v98, 0x3f803f80
    v_mov_b32 v99, 0x3f803f80
    s_mul_i32 s76, s47, 896
    s_lshl_b32 s75, s75, 7
    s_add_u32 s75, s75, s76
    s_add_u32 s75, s75, s42
    v_lshlrev_b32 v9, 1, v2
    s_waitcnt lgkmcnt(6)
    v_mfma_f32_32x32x16_bf16 v[16:31], v[80:83], v[96:99], 0
    s_waitcnt lgkmcnt(4)
    v_mfma_f32_32x32x16_bf16 v[16:31], v[84:87], v[96:99], v[16:31]
    s_waitcnt lgkmcnt(2)
    v_mfma_f32_32x32x16_bf16 v[16:31], v[88:91], v[96:99], v[16:31]
    s_waitcnt lgkmcnt(0)
    v_mfma_f32_32x32x16_bf16 v[16:31], v[92:95], v[96:99], v[16:31]
    s_mov_b32 exec_lo, 1
    s_mov_b32 exec_hi, 1
    s_nop 9
    buffer_store_dwordx4 v[16:19], v9, s[4:7], s75 offen offset:0 sc1
    buffer_store_dwordx4 v[20:23], v9, s[4:7], s75 offen offset:16 sc1
    buffer_store_dwordx4 v[24:27], v9, s[4:7], s75 offen offset:32 sc1
    buffer_store_dwordx4 v[28:31], v9, s[4:7], s75 offen offset:48 sc1
    s_mov_b64 exec, -1
    v_mov_b32 v116, 159256
    s_mov_b32 s77, 0
h_rv5:
    ds_read_b32 v118, v116
    s_add_u32 s77, s77, 1
    s_waitcnt lgkmcnt(0)
    v_readfirstlane_b32 s76, v118
    s_cmp_ge_u32 s77, 160000
    s_cbranch_scc1 h_rd6
    s_cmp_lt_u32 s76, 4
    s_cbranch_scc1 h_rv5
h_rd6:
    s_add_u32 s54, s47, 1
    s_and_b32 s54, s54, 7
    s_mul_i32 s54, s54, 229376
    s_add_u32 m0, s45, 14336
    s_nop 0
    buffer_load_dwordx4 v128, s[12:15], s54 offen lds
    s_add_u32 m0, s45, 15360
    s_nop 0
    buffer_load_dwordx4 v129, s[12:15], s54 offen lds
    s_add_u32 m0, s45, 16384
    s_nop 0
    buffer_load_dwordx4 v130, s[12:15], s54 offen lds
    s_add_u32 m0, s45, 17408
    s_nop 0
    buffer_load_dwordx4 v131, s[12:15], s54 offen lds
    s_add_u32 m0, s45, 18432
    s_nop 0
    buffer_load_dwordx4 v132, s[12:15], s54 offen lds
    s_add_u32 m0, s45, 19456
    s_nop 0
    buffer_load_dwordx4 v133, s[12:15], s54 offen lds
    s_add_u32 m0, s45, 20480
    s_nop 0
    buffer_load_dwordx4 v134, s[12:15], s54 offen lds
    s_add_u32 s54, s47, 2
    s_and_b32 s54, s54, 7
    s_mul_i32 s54, s54, 229376
    s_add_u32 m0, s45, 28672
    s_nop 0
    buffer_load_dwordx4 v128, s[12:15], s54 offen lds
    s_add_u32 m0, s45, 29696
    s_nop 0
    buffer_load_dwordx4 v129, s[12:15], s54 offen lds
    s_add_u32 m0, s45, 30720
    s_nop 0
    buffer_load_dwordx4 v130, s[12:15], s54 offen lds
    s_add_u32 m0, s45, 31744
    s_nop 0
    buffer_load_dwordx4 v131, s[12:15], s54 offen lds
    s_add_u32 m0, s45, 32768
    s_nop 0
    buffer_load_dwordx4 v132, s[12:15], s54 offen lds
    s_add_u32 m0, s45, 33792
    s_nop 0
    buffer_load_dwordx4 v133, s[12:15], s54 offen lds
    s_add_u32 m0, s45, 34816
    s_nop 0
    buffer_load_dwordx4 v134, s[12:15], s54 offen lds
    s_add_u32 s54, s47, 3
    s_and_b32 s54, s54, 7
    s_mul_i32 s54, s54, 229376
    s_add_u32 m0, s45, 43008
    s_nop 0
    buffer_load_dwordx4 v128, s[12:15], s54 offen lds
    s_add_u32 m0, s45, 44032
    s_nop 0
    buffer_load_dwordx4 v129, s[12:15], s54 offen lds
    s_add_u32 m0, s45, 45056
    s_nop 0
    buffer_load_dwordx4 v130, s[12:15], s54 offen lds
    s_add_u32 m0, s45, 46080
    s_nop 0
    buffer_load_dwordx4 v131, s[12:15], s54 offen lds
    s_add_u32 m0, s45, 47104
    s_nop 0
    buffer_load_dwordx4 v132, s[12:15], s54 offen lds
    s_add_u32 m0, s45, 48128
    s_nop 0
    buffer_load_dwordx4 v133, s[12:15], s54 offen lds
    s_add_u32 m0, s45, 49152
    s_nop 0
    buffer_load_dwordx4 v134, s[12:15], s54 offen lds
    v_add_u32 v8, 128, v135
    v_mov_b32 v12, 0
    v_mov_b32 v13, 0
    v_mov_b32 v14, 0
    v_mov_b32 v15, 0
    s_barrier
    s_lshl_b32 s57, s73, 12
    s_mul_i32 s58, s73, 458752
    s_waitcnt vmcnt(22) lgkmcnt(0)
    s_barrier
    ds_read_b64_tr_b16 v[112:113], v136 offset:0
    ds_read_b64_tr_b16 v[114:115], v136 offset:1024
    ds_read_b64_tr_b16 v[80:81], v8 offset:0
    ds_read_b64_tr_b16 v[82:83], v8 offset:896
    ds_read_b64_tr_b16 v[84:85], v8 offset:32
    ds_read_b64_tr_b16 v[86:87], v8 offset:928
    ds_read_b64_tr_b16 v[88:89], v8 offset:64
    ds_read_b64_tr_b16 v[90:91], v8 offset:960
    s_waitcnt lgkmcnt(6)
    s_waitcnt lgkmcnt(4)
    v_mfma_f32_32x32x16_bf16 v[16:31], v[80:83], v[112:115], 0
    ds_read_b64_tr_b16 v[116:117], v136 offset:4096
    ds_read_b64_tr_b16 v[118:119], v136 offset:5120
    ds_read_b64_tr_b16 v[96:97], v8 offset:3584
    ds_read_b64_tr_b16 v[98:99], v8 offset:4480
    v_lshlrev_b32 v138, 16, v114
    v_and_b32 v139, s72, v114
    v_add_f32 v12, v12, v138
    v_add_f32 v13, v13, v139
    s_waitcnt lgkmcnt(6)
    v_mfma_f32_32x32x16_bf16 v[32:47], v[84:87], v[112:115], 0
    ds_read_b64_tr_b16 v[100:101], v8 offset:3616
    ds_read_b64_tr_b16 v[102:103], v8 offset:4512
    ds_read_b64_tr_b16 v[104:105], v8 offset:3648
    ds_read_b64_tr_b16 v[106:107], v8 offset:4544
    v_fmac_f32 v14, v138, v138
    v_fmac_f32 v15, v139, v139
    v_lshlrev_b32 v140, 16, v115
    v_and_b32 v141, s72, v115
    s_waitcnt lgkmcnt(8)
    v_mfma_f32_32x32x16_bf16 v[48:63], v[88:91], v[112:115], 0
    v_add_f32 v12, v12, v140
    v_add_f32 v13, v13, v141
    v_fmac_f32 v14, v140, v140
    v_fmac_f32 v15, v141, v141
    s_waitcnt vmcnt(21) lgkmcnt(0)
    s_barrier
    v_mfma_f32_32x32x16_bf16 v[16:31], v[96:99], v[116:119], v[16:31]
    ds_read_b64_tr_b16 v[112:113], v136 offset:8192
    ds_read_b64_tr_b16 v[114:115], v136 offset:9216
    ds_read_b64_tr_b16 v[80:81], v8 offset:7168
    v_lshlrev_b32 v138, 16, v118
    v_and_b32 v139, s72, v118
    v_add_f32 v12, v12, v138
    v_add_f32 v13, v13, v139
    v_mfma_f32_32x32x16_bf16 v[32:47], v[100:103], v[116:119], v[32:47]
    ds_read_b64_tr_b16 v[82:83], v8 offset:8064
    ds_read_b64_tr_b16 v[84:85], v8 offset:7200
    ds_read_b64_tr_b16 v[86:87], v8 offset:8096
    v_fmac_f32 v14, v138, v138
    v_fmac_f32 v15, v139, v139
    v_lshlrev_b32 v140, 16, v119
    v_and_b32 v141, s72, v119
    v_mfma_f32_32x32x16_bf16 v[48:63], v[104:107], v[116:119], v[48:63]
    ds_read_b64_tr_b16 v[88:89], v8 offset:7232
    ds_read_b64_tr_b16 v[90:91], v8 offset:8128
    v_add_f32 v12, v12, v140
    v_add_f32 v13, v13, v141
    v_fmac_f32 v14, v140, v140
    v_fmac_f32 v15, v141, v141
    s_waitcnt lgkmcnt(6)
    s_waitcnt lgkmcnt(4)
    v_mfma_f32_32x32x16_bf16 v[16:31], v[80:83], v[112:115], v[16:31]
    ds_read_b64_tr_b16 v[116:117], v136 offset:12288
    ds_read_b64_tr_b16 v[118:119], v136 offset:13312
    ds_read_b64_tr_b16 v[96:97], v8 offset:10752
    ds_read_b64_tr_b16 v[98:99], v8 offset:11648
    v_lshlrev_b32 v138, 16, v114
    v_and_b32 v139, s72, v114
    v_add_f32 v12, v12, v138
    v_add_f32 v13, v13, v139
    s_waitcnt lgkmcnt(6)
    v_mfma_f32_32x32x16_bf16 v[32:47], v[84:87], v[112:115], v[32:47]
    ds_read_b64_tr_b16 v[100:101], v8 offset:10784
    ds_read_b64_tr_b16 v[102:103], v8 offset:11680
    ds_read_b64_tr_b16 v[104:105], v8 offset:10816
    ds_read_b64_tr_b16 v[106:107], v8 offset:11712
    v_fmac_f32 v14, v138, v138
    v_fmac_f32 v15, v139, v139
    v_lshlrev_b32 v140, 16, v115
    v_and_b32 v141, s72, v115
    s_waitcnt lgkmcnt(8)
    v_mfma_f32_32x32x16_bf16 v[48:63], v[88:91], v[112:115], v[48:63]
    v_add_f32 v12, v12, v140
    v_add_f32 v13, v13, v141
    v_fmac_f32 v14, v140, v140
    v_fmac_f32 v15, v141, v141
    s_waitcnt vmcnt(14) lgkmcnt(0)
    s_barrier
    v_mfma_f32_32x32x16_bf16 v[16:31], v[96:99], v[116:119], v[16:31]
    ds_read_b64_tr_b16 v[112:113], v136 offset:16384
    ds_read_b64_tr_b16 v[114:115], v136 offset:17408
    ds_read_b64_tr_b16 v[80:81], v8 offset:14336
    v_lshlrev_b32 v138, 16, v118
    v_and_b32 v139, s72, v118
    v_add_f32 v12, v12, v138
    v_add_f32 v13, v13, v139
    s_add_u32 s54, s47, 4
    s_and_b32 s54, s54, 7
    s_mul_i32 s54, s54, 229376
    s_add_u32 m0, s45, 0
    s_nop 0
    buffer_load_dwordx4 v128, s[12:15], s54 offen lds
    v_mfma_f32_32x32x16_bf16 v[32:47], v[100:103], v[116:119], v[32:47]
    ds_read_b64_tr_b16 v[82:83], v8 offset:15232
    ds_read_b64_tr_b16 v[84:85], v8 offset:14368
    ds_read_b64_tr_b16 v[86:87], v8 offset:15264
    v_fmac_f32 v14, v138, v138
    v_fmac_f32 v15, v139, v139
    v_lshlrev_b32 v140, 16, v119
    v_and_b32 v141, s72, v119
    s_add_u32 m0, s45, 1024
    s_nop 0
    buffer_load_dwordx4 v129, s[12:15], s54 offen lds
    v_mfma_f32_32x32x16_bf16 v[48:63], v[104:107], v[116:119], v[48:63]
    ds_read_b64_tr_b16 v[88:89], v8 offset:14400
    ds_read_b64_tr_b16 v[90:91], v8 offset:15296
    v_add_f32 v12, v12, v140
    v_add_f32 v13, v13, v141
    v_fmac_f32 v14, v140, v140
    v_fmac_f32 v15, v141, v141
    s_waitcnt lgkmcnt(6)
    s_waitcnt lgkmcnt(4)
    v_mfma_f32_32x32x16_bf16 v[16:31], v[80:83], v[112:115], v[16:31]
    ds_read_b64_tr_b16 v[116:117], v136 offset:20480
    ds_read_b64_tr_b16 v[118:119], v136 offset:21504
    ds_read_b64_tr_b16 v[96:97], v8 offset:17920
    ds_read_b64_tr_b16 v[98:99], v8 offset:18816
    v_lshlrev_b32 v138, 16, v114
    v_and_b32 v139, s72, v114
    v_add_f32 v12, v12, v138
    v_add_f32 v13, v13, v139
    s_add_u32 m0, s45, 2048
    s_nop 0
    buffer_load_dwordx4 v130, s[12:15], s54 offen lds
    s_waitcnt lgkmcnt(6)
    v_mfma_f32_32x32x16_bf16 v[32:47], v[84:87], v[112:115], v[32:47]
    ds_read_b64_tr_b16 v[100:101], v8 offset:17952
    ds_read_b64_tr_b16 v[102:103], v8 offset:18848
    ds_read_b64_tr_b16 v[104:105], v8 offset:17984
    ds_read_b64_tr_b16 v[106:107], v8 offset:18880
    v_fmac_f32 v14, v138, v138
    v_fmac_f32 v15, v139, v139
    v_lshlrev_b32 v140, 16, v115
    v_and_b32 v141, s72, v115
    s_add_u32 m0, s45, 3072
    s_nop 0
    buffer_load_dwordx4 v131, s[12:15], s54 offen lds
    s_waitcnt lgkmcnt(8)
    v_mfma_f32_32x32x16_bf16 v[48:63], v[88:91], v[112:115], v[48:63]
    v_add_f32 v12, v12, v140
    v_add_f32 v13, v13, v141
    v_fmac_f32 v14, v140, v140
    v_fmac_f32 v15, v141, v141
    s_waitcnt lgkmcnt(0)
    s_barrier
    v_mfma_f32_32x32x16_bf16 v[16:31], v[96:99], v[116:119], v[16:31]
    ds_read_b64_tr_b16 v[112:113], v136 offset:24576
    ds_read_b64_tr_b16 v[114:115], v136 offset:25600
    ds_read_b64_tr_b16 v[80:81], v8 offset:21504
    v_lshlrev_b32 v138, 16, v118
    v_and_b32 v139, s72, v118
    v_add_f32 v12, v12, v138
    v_add_f32 v13, v13, v139
    s_add_u32 m0, s45, 4096
    s_nop 0
    buffer_load_dwordx4 v132, s[12:15], s54 offen lds
    v_mfma_f32_32x32x16_bf16 v[32:47], v[100:103], v[116:119], v[32:47]
    ds_read_b64_tr_b16 v[82:83], v8 offset:22400
    ds_read_b64_tr_b16 v[84:85], v8 offset:21536
    ds_read_b64_tr_b16 v[86:87], v8 offset:22432
    v_fmac_f32 v14, v138, v138
    v_fmac_f32 v15, v139, v139
    v_lshlrev_b32 v140, 16, v119
    v_and_b32 v141, s72, v119
    s_add_u32 m0, s45, 5120
    s_nop 0
    buffer_load_dwordx4 v133, s[12:15], s54 offen lds
    v_mfma_f32_32x32x16_bf16 v[48:63], v[104:107], v[116:119], v[48:63]
    ds_read_b64_tr_b16 v[88:89], v8 offset:21568
    ds_read_b64_tr_b16 v[90:91], v8 offset:22464
    v_add_f32 v12, v12, v140
    v_add_f32 v13, v13, v141
    v_fmac_f32 v14, v140, v140
    v_fmac_f32 v15, v141, v141
    s_waitcnt lgkmcnt(6)
    s_waitcnt lgkmcnt(4)
    v_mfma_f32_32x32x16_bf16 v[16:31], v[80:83], v[112:115], v[16:31]
    ds_read_b64_tr_b16 v[116:117], v136 offset:28672
    ds_read_b64_tr_b16 v[118:119], v136 offset:29696
    ds_read_b64_tr_b16 v[96:97], v8 offset:25088
    ds_read_b64_tr_b16 v[98:99], v8 offset:25984
    v_lshlrev_b32 v138, 16, v114
    v_and_b32 v139, s72, v114
    v_add_f32 v12, v12, v138
    v_add_f32 v13, v13, v139
    s_add_u32 m0, s45, 6144
    s_nop 0
    buffer_load_dwordx4 v134, s[12:15], s54 offen lds
    s_waitcnt lgkmcnt(6)
    v_mfma_f32_32x32x16_bf16 v[32:47], v[84:87], v[112:115], v[32:47]
    ds_read_b64_tr_b16 v[100:101], v8 offset:25120
    ds_read_b64_tr_b16 v[102:103], v8 offset:26016
    ds_read_b64_tr_b16 v[104:105], v8 offset:25152
    ds_read_b64_tr_b16 v[106:107], v8 offset:26048
    v_fmac_f32 v14, v138, v138
    v_fmac_f32 v15, v139, v139
    v_lshlrev_b32 v140, 16, v115
    v_and_b32 v141, s72, v115
    s_waitcnt lgkmcnt(8)
    v_mfma_f32_32x32x16_bf16 v[48:63], v[88:91], v[112:115], v[48:63]
    v_add_f32 v12, v12, v140
    v_add_f32 v13, v13, v141
    v_fmac_f32 v14, v140, v140
    v_fmac_f32 v15, v141, v141
    s_waitcnt vmcnt(14) lgkmcnt(0)
    s_barrier
    v_mfma_f32_32x32x16_bf16 v[16:31], v[96:99], v[116:119], v[16:31]
    ds_read_b64_tr_b16 v[112:113], v136 offset:32768
    ds_read_b64_tr_b16 v[114:115], v136 offset:33792
    ds_read_b64_tr_b16 v[80:81], v8 offset:28672
    v_lshlrev_b32 v138, 16, v118
    v_and_b32 v139, s72, v118
    v_add_f32 v12, v12, v138
    v_add_f32 v13, v13, v139
    s_add_u32 s54, s47, 5
    s_and_b32 s54, s54, 7
    s_mul_i32 s54, s54, 229376
    s_add_u32 m0, s45, 14336
    s_nop 0
    buffer_load_dwordx4 v128, s[12:15], s54 offen lds
    v_mfma_f32_32x32x16_bf16 v[32:47], v[100:103], v[116:119], v[32:47]
    ds_read_b64_tr_b16 v[82:83], v8 offset:29568
    ds_read_b64_tr_b16 v[84:85], v8 offset:28704
    ds_read_b64_tr_b16 v[86:87], v8 offset:29600
    v_fmac_f32 v14, v138, v138
    v_fmac_f32 v15, v139, v139
    v_lshlrev_b32 v140, 16, v119
    v_and_b32 v141, s72, v119
    s_add_u32 m0, s45, 15360
    s_nop 0
    buffer_load_dwordx4 v129, s[12:15], s54 offen lds
    v_mfma_f32_32x32x16_bf16 v[48:63], v[104:107], v[116:119], v[48:63]
    ds_read_b64_tr_b16 v[88:89], v8 offset:28736
    ds_read_b64_tr_b16 v[90:91], v8 offset:29632
    v_add_f32 v12, v12, v140
    v_add_f32 v13, v13, v141
    v_fmac_f32 v14, v140, v140
    v_fmac_f32 v15, v141, v141
    s_waitcnt lgkmcnt(6)
    s_waitcnt lgkmcnt(4)
    v_mfma_f32_32x32x16_bf16 v[16:31], v[80:83], v[112:115], v[16:31]
    ds_read_b64_tr_b16 v[116:117], v136 offset:36864
    ds_read_b64_tr_b16 v[118:119], v136 offset:37888
    ds_read_b64_tr_b16 v[96:97], v8 offset:32256
    ds_read_b64_tr_b16 v[98:99], v8 offset:33152
    v_lshlrev_b32 v138, 16, v114
    v_and_b32 v139, s72, v114
    v_add_f32 v12, v12, v138
    v_add_f32 v13, v13, v139
    s_add_u32 m0, s45, 16384
    s_nop 0
    buffer_load_dwordx4 v130, s[12:15], s54 offen lds
    s_waitcnt lgkmcnt(6)
    v_mfma_f32_32x32x16_bf16 v[32:47], v[84:87], v[112:115], v[32:47]
    ds_read_b64_tr_b16 v[100:101], v8 offset:32288
    ds_read_b64_tr_b16 v[102:103], v8 offset:33184
    ds_read_b64_tr_b16 v[104:105], v8 offset:32320
    ds_read_b64_tr_b16 v[106:107], v8 offset:33216
    v_fmac_f32 v14, v138, v138
    v_fmac_f32 v15, v139, v139
    v_lshlrev_b32 v140, 16, v115
    v_and_b32 v141, s72, v115
    s_add_u32 m0, s45, 17408
    s_nop 0
    buffer_load_dwordx4 v131, s[12:15], s54 offen lds
    s_waitcnt lgkmcnt(8)
    v_mfma_f32_32x32x16_bf16 v[48:63], v[88:91], v[112:115], v[48:63]
    v_add_f32 v12, v12, v140
    v_add_f32 v13, v13, v141
    v_fmac_f32 v14, v140, v140
    v_fmac_f32 v15, v141, v141
    s_waitcnt lgkmcnt(0)
    s_barrier
    v_mfma_f32_32x32x16_bf16 v[16:31], v[96:99], v[116:119], v[16:31]
    ds_read_b64_tr_b16 v[112:113], v136 offset:0
    ds_read_b64_tr_b16 v[114:115], v136 offset:1024
    ds_read_b64_tr_b16 v[80:81], v8 offset:35840
    v_lshlrev_b32 v138, 16, v118
    v_and_b32 v139, s72, v118
    v_add_f32 v12, v12, v138
    v_add_f32 v13, v13, v139
    s_add_u32 m0, s45, 18432
    s_nop 0
    buffer_load_dwordx4 v132, s[12:15], s54 offen lds
    v_mfma_f32_32x32x16_bf16 v[32:47], v[100:103], v[116:119], v[32:47]
    ds_read_b64_tr_b16 v[82:83], v8 offset:36736
    ds_read_b64_tr_b16 v[84:85], v8 offset:35872
    ds_read_b64_tr_b16 v[86:87], v8 offset:36768
    v_fmac_f32 v14, v138, v138
    v_fmac_f32 v15, v139, v139
    v_lshlrev_b32 v140, 16, v119
    v_and_b32 v141, s72, v119
    s_add_u32 m0, s45, 19456
    s_nop 0
    buffer_load_dwordx4 v133, s[12:15], s54 offen lds
    v_mfma_f32_32x32x16_bf16 v[48:63], v[104:107], v[116:119], v[48:63]
    ds_read_b64_tr_b16 v[88:89], v8 offset:35904
    ds_read_b64_tr_b16 v[90:91], v8 offset:36800
    v_add_f32 v12, v12, v140
    v_add_f32 v13, v13, v141
    v_fmac_f32 v14, v140, v140
    v_fmac_f32 v15, v141, v141
    s_waitcnt lgkmcnt(6)
    s_waitcnt lgkmcnt(4)
    v_mfma_f32_32x32x16_bf16 v[16:31], v[80:83], v[112:115], v[16:31]
    ds_read_b64_tr_b16 v[116:117], v136 offset:4096
    ds_read_b64_tr_b16 v[118:119], v136 offset:5120
    ds_read_b64_tr_b16 v[96:97], v8 offset:39424
    ds_read_b64_tr_b16 v[98:99], v8 offset:40320
    v_lshlrev_b32 v138, 16, v114
    v_and_b32 v139, s72, v114
    v_add_f32 v12, v12, v138
    v_add_f32 v13, v13, v139
    s_add_u32 m0, s45, 20480
    s_nop 0
    buffer_load_dwordx4 v134, s[12:15], s54 offen lds
    s_waitcnt lgkmcnt(6)
    v_mfma_f32_32x32x16_bf16 v[32:47], v[84:87], v[112:115], v[32:47]
    ds_read_b64_tr_b16 v[100:101], v8 offset:39456
    ds_read_b64_tr_b16 v[102:103], v8 offset:40352
    ds_read_b64_tr_b16 v[104:105], v8 offset:39488
    ds_read_b64_tr_b16 v[106:107], v8 offset:40384
    v_fmac_f32 v14, v138, v138
    v_fmac_f32 v15, v139, v139
    v_lshlrev_b32 v140, 16, v115
    v_and_b32 v141, s72, v115
    s_waitcnt lgkmcnt(8)
    v_mfma_f32_32x32x16_bf16 v[48:63], v[88:91], v[112:115], v[48:63]
    v_add_f32 v12, v12, v140
    v_add_f32 v13, v13, v141
    v_fmac_f32 v14, v140, v140
    v_fmac_f32 v15, v141, v141
    s_waitcnt vmcnt(14) lgkmcnt(0)
    s_barrier
    v_mfma_f32_32x32x16_bf16 v[16:31], v[96:99], v[116:119], v[16:31]
    ds_read_b64_tr_b16 v[112:113], v136 offset:8192
    ds_read_b64_tr_b16 v[114:115], v136 offset:9216
    ds_read_b64_tr_b16 v[80:81], v8 offset:43008
    v_lshlrev_b32 v138, 16, v118
    v_and_b32 v139, s72, v118
    v_add_f32 v12, v12, v138
    v_add_f32 v13, v13, v139
    s_add_u32 s54, s47, 6
    s_and_b32 s54, s54, 7
    s_mul_i32 s54, s54, 229376
    s_add_u32 m0, s45, 28672
    s_nop 0
    buffer_load_dwordx4 v128, s[12:15], s54 offen lds
    v_mfma_f32_32x32x16_bf16 v[32:47], v[100:103], v[116:119], v[32:47]
    ds_read_b64_tr_b16 v[82:83], v8 offset:43904
    ds_read_b64_tr_b16 v[84:85], v8 offset:43040
    ds_read_b64_tr_b16 v[86:87], v8 offset:43936
    v_fmac_f32 v14, v138, v138
    v_fmac_f32 v15, v139, v139
    v_lshlrev_b32 v140, 16, v119
    v_and_b32 v141, s72, v119
    s_add_u32 m0, s45, 29696
    s_nop 0
    buffer_load_dwordx4 v129, s[12:15], s54 offen lds
    v_mfma_f32_32x32x16_bf16 v[48:63], v[104:107], v[116:119], v[48:63]
    ds_read_b64_tr_b16 v[88:89], v8 offset:43072
    ds_read_b64_tr_b16 v[90:91], v8 offset:43968
    v_add_f32 v12, v12, v140
    v_add_f32 v13, v13, v141
    v_fmac_f32 v14, v140, v140
    v_fmac_f32 v15, v141, v141
    s_waitcnt lgkmcnt(6)
    s_waitcnt lgkmcnt(4)
    v_mfma_f32_32x32x16_bf16 v[16:31], v[80:83], v[112:115], v[16:31]
    ds_read_b64_tr_b16 v[116:117], v136 offset:12288
    ds_read_b64_tr_b16 v[118:119], v136 offset:13312
    ds_read_b64_tr_b16 v[96:97], v8 offset:46592
    ds_read_b64_tr_b16 v[98:99], v8 offset:47488
    v_lshlrev_b32 v138, 16, v114
    v_and_b32 v139, s72, v114
    v_add_f32 v12, v12, v138
    v_add_f32 v13, v13, v139
    s_add_u32 m0, s45, 30720
    s_nop 0
    buffer_load_dwordx4 v130, s[12:15], s54 offen lds
    s_waitcnt lgkmcnt(6)
    v_mfma_f32_32x32x16_bf16 v[32:47], v[84:87], v[112:115], v[32:47]
    ds_read_b64_tr_b16 v[100:101], v8 offset:46624
    ds_read_b64_tr_b16 v[102:103], v8 offset:47520
    ds_read_b64_tr_b16 v[104:105], v8 offset:46656
    ds_read_b64_tr_b16 v[106:107], v8 offset:47552
    v_fmac_f32 v14, v138, v138
    v_fmac_f32 v15, v139, v139
    v_lshlrev_b32 v140, 16, v115
    v_and_b32 v141, s72, v115
    s_add_u32 m0, s45, 31744
    s_nop 0
    buffer_load_dwordx4 v131, s[12:15], s54 offen lds
    s_waitcnt lgkmcnt(8)
    v_mfma_f32_32x32x16_bf16 v[48:63], v[88:91], v[112:115], v[48:63]
    v_add_f32 v12, v12, v140
    v_add_f32 v13, v13, v141
    v_fmac_f32 v14, v140, v140
    v_fmac_f32 v15, v141, v141
    s_waitcnt lgkmcnt(0)
    s_barrier
    v_mfma_f32_32x32x16_bf16 v[16:31], v[96:99], v[116:119], v[16:31]
    ds_read_b64_tr_b16 v[112:113], v136 offset:16384
    ds_read_b64_tr_b16 v[114:115], v136 offset:17408
    ds_read_b64_tr_b16 v[80:81], v8 offset:50176
    v_lshlrev_b32 v138, 16, v118
    v_and_b32 v139, s72, v118
    v_add_f32 v12, v12, v138
    v_add_f32 v13, v13, v139
    s_add_u32 m0, s45, 32768
    s_nop 0
    buffer_load_dwordx4 v132, s[12:15], s54 offen lds
    v_mfma_f32_32x32x16_bf16 v[32:47], v[100:103], v[116:119], v[32:47]
    ds_read_b64_tr_b16 v[82:83], v8 offset:51072
    ds_read_b64_tr_b16 v[84:85], v8 offset:50208
    ds_read_b64_tr_b16 v[86:87], v8 offset:51104
    v_fmac_f32 v14, v138, v138
    v_fmac_f32 v15, v139, v139
    v_lshlrev_b32 v140, 16, v119
    v_and_b32 v141, s72, v119
    s_add_u32 m0, s45, 33792
    s_nop 0
    buffer_load_dwordx4 v133, s[12:15], s54 offen lds
    v_mfma_f32_32x32x16_bf16 v[48:63], v[104:107], v[116:119], v[48:63]
    ds_read_b64_tr_b16 v[88:89], v8 offset:50240
    ds_read_b64_tr_b16 v[90:91], v8 offset:51136
    v_add_f32 v12, v12, v140
    v_add_f32 v13, v13, v141
    v_fmac_f32 v14, v140, v140
    v_fmac_f32 v15, v141, v141
    s_waitcnt lgkmcnt(6)
    s_waitcnt lgkmcnt(4)
    v_mfma_f32_32x32x16_bf16 v[16:31], v[80:83], v[112:115], v[16:31]
    ds_read_b64_tr_b16 v[116:117], v136 offset:20480
    ds_read_b64_tr_b16 v[118:119], v136 offset:21504
    ds_read_b64_tr_b16 v[96:97], v8 offset:53760
    ds_read_b64_tr_b16 v[98:99], v8 offset:54656
    v_lshlrev_b32 v138, 16, v114
    v_and_b32 v139, s72, v114
    v_add_f32 v12, v12, v138
    v_add_f32 v13, v13, v139
    s_add_u32 m0, s45, 34816
    s_nop 0
    buffer_load_dwordx4 v134, s[12:15], s54 offen lds
    s_waitcnt lgkmcnt(6)
    v_mfma_f32_32x32x16_bf16 v[32:47], v[84:87], v[112:115], v[32:47]
    ds_read_b64_tr_b16 v[100:101], v8 offset:53792
    ds_read_b64_tr_b16 v[102:103], v8 offset:54688
    ds_read_b64_tr_b16 v[104:105], v8 offset:53824
    ds_read_b64_tr_b16 v[106:107], v8 offset:54720
    v_fmac_f32 v14, v138, v138
    v_fmac_f32 v15, v139, v139
    v_lshlrev_b32 v140, 16, v115
    v_and_b32 v141, s72, v115
    s_waitcnt lgkmcnt(8)
    v_mfma_f32_32x32x16_bf16 v[48:63], v[88:91], v[112:115], v[48:63]
    v_add_f32 v12, v12, v140
    v_add_f32 v13, v13, v141
    v_fmac_f32 v14, v140, v140
    v_fmac_f32 v15, v141, v141
    s_waitcnt vmcnt(14) lgkmcnt(0)
    s_barrier
    v_mfma_f32_32x32x16_bf16 v[16:31], v[96:99], v[116:119], v[16:31]
    ds_read_b64_tr_b16 v[112:113], v136 offset:24576
    ds_read_b64_tr_b16 v[114:115], v136 offset:25600
    ds_read_b64_tr_b16 v[80:81], v8 offset:0
    v_lshlrev_b32 v138, 16, v118
    v_and_b32 v139, s72, v118
    v_add_f32 v12, v12, v138
    v_add_f32 v13, v13, v139
    s_add_u32 s54, s47, 7
    s_and_b32 s54, s54, 7
    s_mul_i32 s54, s54, 229376
    s_add_u32 m0, s45, 43008
    s_nop 0
    buffer_load_dwordx4 v128, s[12:15], s54 offen lds
    v_mfma_f32_32x32x16_bf16 v[32:47], v[100:103], v[116:119], v[32:47]
    ds_read_b64_tr_b16 v[82:83], v8 offset:896
    ds_read_b64_tr_b16 v[84:85], v8 offset:32
    ds_read_b64_tr_b16 v[86:87], v8 offset:928
    v_fmac_f32 v14, v138, v138
    v_fmac_f32 v15, v139, v139
    v_lshlrev_b32 v140, 16, v119
    v_and_b32 v141, s72, v119
    s_add_u32 m0, s45, 44032
    s_nop 0
    buffer_load_dwordx4 v129, s[12:15], s54 offen lds
    v_mfma_f32_32x32x16_bf16 v[48:63], v[104:107], v[116:119], v[48:63]
    ds_read_b64_tr_b16 v[88:89], v8 offset:64
    ds_read_b64_tr_b16 v[90:91], v8 offset:960
    v_add_f32 v12, v12, v140
    v_add_f32 v13, v13, v141
    v_fmac_f32 v14, v140, v140
    v_fmac_f32 v15, v141, v141
    s_waitcnt lgkmcnt(6)
    s_waitcnt lgkmcnt(4)
    v_mfma_f32_32x32x16_bf16 v[16:31], v[80:83], v[112:115], v[16:31]
    ds_read_b64_tr_b16 v[116:117], v136 offset:28672
    ds_read_b64_tr_b16 v[118:119], v136 offset:29696
    ds_read_b64_tr_b16 v[96:97], v8 offset:3584
    ds_read_b64_tr_b16 v[98:99], v8 offset:4480
    v_lshlrev_b32 v138, 16, v114
    v_and_b32 v139, s72, v114
    v_add_f32 v12, v12, v138
    v_add_f32 v13, v13, v139
    s_add_u32 m0, s45, 45056
    s_nop 0
    buffer_load_dwordx4 v130, s[12:15], s54 offen lds
    s_waitcnt lgkmcnt(6)
    v_mfma_f32_32x32x16_bf16 v[32:47], v[84:87], v[112:115], v[32:47]
    ds_read_b64_tr_b16 v[100:101], v8 offset:3616
    ds_read_b64_tr_b16 v[102:103], v8 offset:4512
    ds_read_b64_tr_b16 v[104:105], v8 offset:3648
    ds_read_b64_tr_b16 v[106:107], v8 offset:4544
    v_fmac_f32 v14, v138, v138
    v_fmac_f32 v15, v139, v139
    v_lshlrev_b32 v140, 16, v115
    v_and_b32 v141, s72, v115
    s_add_u32 m0, s45, 46080
    s_nop 0
    buffer_load_dwordx4 v131, s[12:15], s54 offen lds
    s_waitcnt lgkmcnt(8)
    v_mfma_f32_32x32x16_bf16 v[48:63], v[88:91], v[112:115], v[48:63]
    v_add_f32 v12, v12, v140
    v_add_f32 v13, v13, v141
    v_fmac_f32 v14, v140, v140
    v_fmac_f32 v15, v141, v141
    s_waitcnt lgkmcnt(0)
    s_barrier
    v_mfma_f32_32x32x16_bf16 v[16:31], v[96:99], v[116:119], v[16:31]
    ds_read_b64_tr_b16 v[112:113], v136 offset:32768
    ds_read_b64_tr_b16 v[114:115], v136 offset:33792
    ds_read_b64_tr_b16 v[80:81], v8 offset:7168
    v_lshlrev_b32 v138, 16, v118
    v_and_b32 v139, s72, v118
    v_add_f32 v12, v12, v138
    v_add_f32 v13, v13, v139
    s_add_u32 m0, s45, 47104
    s_nop 0
    buffer_load_dwordx4 v132, s[12:15], s54 offen lds
    v_mfma_f32_32x32x16_bf16 v[32:47], v[100:103], v[116:119], v[32:47]
    ds_read_b64_tr_b16 v[82:83], v8 offset:8064
    ds_read_b64_tr_b16 v[84:85], v8 offset:7200
    ds_read_b64_tr_b16 v[86:87], v8 offset:8096
    v_fmac_f32 v14, v138, v138
    v_fmac_f32 v15, v139, v139
    v_lshlrev_b32 v140, 16, v119
    v_and_b32 v141, s72, v119
    s_add_u32 m0, s45, 48128
    s_nop 0
    buffer_load_dwordx4 v133, s[12:15], s54 offen lds
    v_mfma_f32_32x32x16_bf16 v[48:63], v[104:107], v[116:119], v[48:63]
    ds_read_b64_tr_b16 v[88:89], v8 offset:7232
    ds_read_b64_tr_b16 v[90:91], v8 offset:8128
    v_add_f32 v12, v12, v140
    v_add_f32 v13, v13, v141
    v_fmac_f32 v14, v140, v140
    v_fmac_f32 v15, v141, v141
    s_waitcnt lgkmcnt(6)
    s_waitcnt lgkmcnt(4)
    v_mfma_f32_32x32x16_bf16 v[16:31], v[80:83], v[112:115], v[16:31]
    ds_read_b64_tr_b16 v[116:117], v136 offset:36864
    ds_read_b64_tr_b16 v[118:119], v136 offset:37888
    ds_read_b64_tr_b16 v[96:97], v8 offset:10752
    ds_read_b64_tr_b16 v[98:99], v8 offset:11648
    v_lshlrev_b32 v138, 16, v114
    v_and_b32 v139, s72, v114
    v_add_f32 v12, v12, v138
    v_add_f32 v13, v13, v139
    s_add_u32 m0, s45, 49152
    s_nop 0
    buffer_load_dwordx4 v134, s[12:15], s54 offen lds
    s_waitcnt lgkmcnt(6)
    v_mfma_f32_32x32x16_bf16 v[32:47], v[84:87], v[112:115], v[32:47]
    ds_read_b64_tr_b16 v[100:101], v8 offset:10784
    ds_read_b64_tr_b16 v[102:103], v8 offset:11680
    ds_read_b64_tr_b16 v[104:105], v8 offset:10816
    ds_read_b64_tr_b16 v[106:107], v8 offset:11712
    v_fmac_f32 v14, v138, v138
    v_fmac_f32 v15, v139, v139
    v_lshlrev_b32 v140, 16, v115
    v_and_b32 v141, s72, v115
    s_waitcnt lgkmcnt(8)
    v_mfma_f32_32x32x16_bf16 v[48:63], v[88:91], v[112:115], v[48:63]
    v_add_f32 v12, v12, v140
    v_add_f32 v13, v13, v141
    v_fmac_f32 v14, v140, v140
    v_fmac_f32 v15, v141, v141
    s_waitcnt vmcnt(14) lgkmcnt(0)
    s_barrier
    v_mfma_f32_32x32x16_bf16 v[16:31], v[96:99], v[116:119], v[16:31]
    ds_read_b64_tr_b16 v[112:113], v136 offset:0
    ds_read_b64_tr_b16 v[114:115], v136 offset:1024
    ds_read_b64_tr_b16 v[80:81], v8 offset:14336
    v_lshlrev_b32 v138, 16, v118
    v_and_b32 v139, s72, v118
    v_add_f32 v12, v12, v138
    v_add_f32 v13, v13, v139
    s_add_u32 m0, s45, 0
    s_add_u32 s53, s46, 196608
    buffer_load_dwordx4 v4, s[16:19], s53 offen lds
    v_mfma_f32_32x32x16_bf16 v[32:47], v[100:103], v[116:119], v[32:47]
    ds_read_b64_tr_b16 v[82:83], v8 offset:15232
    ds_read_b64_tr_b16 v[84:85], v8 offset:14368
    ds_read_b64_tr_b16 v[86:87], v8 offset:15264
    v_fmac_f32 v14, v138, v138
    v_fmac_f32 v15, v139, v139
    v_lshlrev_b32 v140, 16, v119
    v_and_b32 v141, s72, v119
    s_add_u32 m0, s45, 1024
    s_add_u32 s53, s46, 204800
    buffer_load_dwordx4 v4, s[16:19], s53 offen lds
    v_mfma_f32_32x32x16_bf16 v[48:63], v[104:107], v[116:119], v[48:63]
    ds_read_b64_tr_b16 v[88:89], v8 offset:14400
    ds_read_b64_tr_b16 v[90:91], v8 offset:15296
    v_add_f32 v12, v12, v140
    v_add_f32 v13, v13, v141
    v_fmac_f32 v14, v140, v140
    v_fmac_f32 v15, v141, v141
    s_waitcnt lgkmcnt(6)
    s_waitcnt lgkmcnt(4)
    v_mfma_f32_32x32x16_bf16 v[16:31], v[80:83], v[112:115], v[16:31]
    ds_read_b64_tr_b16 v[116:117], v136 offset:4096
    ds_read_b64_tr_b16 v[118:119], v136 offset:5120
    ds_read_b64_tr_b16 v[96:97], v8 offset:17920
    ds_read_b64_tr_b16 v[98:99], v8 offset:18816
    v_lshlrev_b32 v138, 16, v114
    v_and_b32 v139, s72, v114
    v_add_f32 v12, v12, v138
    v_add_f32 v13, v13, v139
    s_add_u32 m0, s45, 2048
    s_add_u32 s53, s46, 212992
    buffer_load_dwordx4 v4, s[16:19], s53 offen lds
    s_waitcnt lgkmcnt(6)
    v_mfma_f32_32x32x16_bf16 v[32:47], v[84:87], v[112:115], v[32:47]
    ds_read_b64_tr_b16 v[100:101], v8 offset:17952
    ds_read_b64_tr_b16 v[102:103], v8 offset:18848
    ds_read_b64_tr_b16 v[104:105], v8 offset:17984
    ds_read_b64_tr_b16 v[106:107], v8 offset:18880
    v_fmac_f32 v14, v138, v138
    v_fmac_f32 v15, v139, v139
    v_lshlrev_b32 v140, 16, v115
    v_and_b32 v141, s72, v115
    s_add_u32 m0, s45, 3072
    s_add_u32 s53, s46, 221184
    buffer_load_dwordx4 v4, s[16:19], s53 offen lds
    s_waitcnt lgkmcnt(8)
    v_mfma_f32_32x32x16_bf16 v[48:63], v[88:91], v[112:115], v[48:63]
    v_add_f32 v12, v12, v140
    v_add_f32 v13, v13, v141
    v_fmac_f32 v14, v140, v140
    v_fmac_f32 v15, v141, v141
    s_waitcnt lgkmcnt(0)
    s_barrier
    v_mfma_f32_32x32x16_bf16 v[16:31], v[96:99], v[116:119], v[16:31]
    ds_read_b64_tr_b16 v[112:113], v136 offset:8192
    ds_read_b64_tr_b16 v[114:115], v136 offset:9216
    ds_read_b64_tr_b16 v[80:81], v8 offset:21504
    v_lshlrev_b32 v138, 16, v118
    v_and_b32 v139, s72, v118
    v_add_f32 v12, v12, v138
    v_add_f32 v13, v13, v139
    s_add_u32 m0, s45, 4096
    s_add_u32 s53, s46, 229376
    buffer_load_dwordx4 v4, s[16:19], s53 offen lds
    v_mfma_f32_32x32x16_bf16 v[32:47], v[100:103], v[116:119], v[32:47]
    ds_read_b64_tr_b16 v[82:83], v8 offset:22400
    ds_read_b64_tr_b16 v[84:85], v8 offset:21536
    ds_read_b64_tr_b16 v[86:87], v8 offset:22432
    v_fmac_f32 v14, v138, v138
    v_fmac_f32 v15, v139, v139
    v_lshlrev_b32 v140, 16, v119
    v_and_b32 v141, s72, v119
    s_add_u32 m0, s45, 5120
    s_add_u32 s53, s46, 237568
    buffer_load_dwordx4 v4, s[16:19], s53 offen lds
    v_mfma_f32_32x32x16_bf16 v[48:63], v[104:107], v[116:119], v[48:63]
    ds_read_b64_tr_b16 v[88:89], v8 offset:21568
    ds_read_b64_tr_b16 v[90:91], v8 offset:22464
    v_add_f32 v12, v12, v140
    v_add_f32 v13, v13, v141
    v_fmac_f32 v14, v140, v140
    v_fmac_f32 v15, v141, v141
    s_waitcnt lgkmcnt(6)
    s_waitcnt lgkmcnt(4)
    v_mfma_f32_32x32x16_bf16 v[16:31], v[80:83], v[112:115], v[16:31]
    ds_read_b64_tr_b16 v[116:117], v136 offset:12288
    ds_read_b64_tr_b16 v[118:119], v136 offset:13312
    ds_read_b64_tr_b16 v[96:97], v8 offset:25088
    ds_read_b64_tr_b16 v[98:99], v8 offset:25984
    v_lshlrev_b32 v138, 16, v114
    v_and_b32 v139, s72, v114
    v_add_f32 v12, v12, v138
    v_add_f32 v13, v13, v139
    s_add_u32 m0, s45, 6144
    s_add_u32 s53, s46, 245760
    buffer_load_dwordx4 v4, s[16:19], s53 offen lds
    s_waitcnt lgkmcnt(6)
    v_mfma_f32_32x32x16_bf16 v[32:47], v[84:87], v[112:115], v[32:47]
    ds_read_b64_tr_b16 v[100:101], v8 offset:25120
    ds_read_b64_tr_b16 v[102:103], v8 offset:26016
    ds_read_b64_tr_b16 v[104:105], v8 offset:25152
    ds_read_b64_tr_b16 v[106:107], v8 offset:26048
    v_fmac_f32 v14, v138, v138
    v_fmac_f32 v15, v139, v139
    v_lshlrev_b32 v140, 16, v115
    v_and_b32 v141, s72, v115
    s_waitcnt lgkmcnt(8)
    v_mfma_f32_32x32x16_bf16 v[48:63], v[88:91], v[112:115], v[48:63]
    v_add_f32 v12, v12, v140
    v_add_f32 v13, v13, v141
    v_fmac_f32 v14, v140, v140
    v_fmac_f32 v15, v141, v141
    s_waitcnt vmcnt(14) lgkmcnt(0)
    s_barrier
    v_mfma_f32_32x32x16_bf16 v[16:31], v[96:99], v[116:119], v[16:31]
    ds_read_b64_tr_b16 v[112:113], v136 offset:16384
    ds_read_b64_tr_b16 v[114:115], v136 offset:17408
    ds_read_b64_tr_b16 v[80:81], v8 offset:28672
    v_lshlrev_b32 v138, 16, v118
    v_and_b32 v139, s72, v118
    v_add_f32 v12, v12, v138
    v_add_f32 v13, v13, v139
    s_add_u32 m0, s45, 14336
    s_add_u32 s53, s46, 655360
    buffer_load_dwordx4 v4, s[16:19], s53 offen lds
    v_mfma_f32_32x32x16_bf16 v[32:47], v[100:103], v[116:119], v[32:47]
    ds_read_b64_tr_b16 v[82:83], v8 offset:29568
    ds_read_b64_tr_b16 v[84:85], v8 offset:28704
    ds_read_b64_tr_b16 v[86:87], v8 offset:29600
    v_fmac_f32 v14, v138, v138
    v_fmac_f32 v15, v139, v139
    v_lshlrev_b32 v140, 16, v119
    v_and_b32 v141, s72, v119
    s_add_u32 m0, s45, 15360
    s_add_u32 s53, s46, 663552
    buffer_load_dwordx4 v4, s[16:19], s53 offen lds
    v_mfma_f32_32x32x16_bf16 v[48:63], v[104:107], v[116:119], v[48:63]
    ds_read_b64_tr_b16 v[88:89], v8 offset:28736
    ds_read_b64_tr_b16 v[90:91], v8 offset:29632
    v_add_f32 v12, v12, v140
    v_add_f32 v13, v13, v141
    v_fmac_f32 v14, v140, v140
    v_fmac_f32 v15, v141, v141
    s_waitcnt lgkmcnt(6)
    s_waitcnt lgkmcnt(4)
    v_mfma_f32_32x32x16_bf16 v[16:31], v[80:83], v[112:115], v[16:31]
    ds_read_b64_tr_b16 v[116:117], v136 offset:20480
    ds_read_b64_tr_b16 v[118:119], v136 offset:21504
    ds_read_b64_tr_b16 v[96:97], v8 offset:32256
    ds_read_b64_tr_b16 v[98:99], v8 offset:33152
    v_lshlrev_b32 v138, 16, v114
    v_and_b32 v139, s72, v114
    v_add_f32 v12, v12, v138
    v_add_f32 v13, v13, v139
    s_add_u32 m0, s45, 16384
    s_add_u32 s53, s46, 671744
    buffer_load_dwordx4 v4, s[16:19], s53 offen lds
    s_waitcnt lgkmcnt(6)
    v_mfma_f32_32x32x16_bf16 v[32:47], v[84:87], v[112:115], v[32:47]
    ds_read_b64_tr_b16 v[100:101], v8 offset:32288
    ds_read_b64_tr_b16 v[102:103], v8 offset:33184
    ds_read_b64_tr_b16 v[104:105], v8 offset:32320
    ds_read_b64_tr_b16 v[106:107], v8 offset:33216
    v_fmac_f32 v14, v138, v138
    v_fmac_f32 v15, v139, v139
    v_lshlrev_b32 v140, 16, v115
    v_and_b32 v141, s72, v115
    s_add_u32 m0, s45, 17408
    s_add_u32 s53, s46, 679936
    buffer_load_dwordx4 v4, s[16:19], s53 offen lds
    s_waitcnt lgkmcnt(8)
    v_mfma_f32_32x32x16_bf16 v[48:63], v[88:91], v[112:115], v[48:63]
    v_add_f32 v12, v12, v140
    v_add_f32 v13, v13, v141
    v_fmac_f32 v14, v140, v140
    v_fmac_f32 v15, v141, v141
    s_waitcnt lgkmcnt(0)
    s_barrier
    v_mfma_f32_32x32x16_bf16 v[16:31], v[96:99], v[116:119], v[16:31]
    ds_read_b64_tr_b16 v[112:113], v136 offset:24576
    ds_read_b64_tr_b16 v[114:115], v136 offset:25600
    ds_read_b64_tr_b16 v[80:81], v8 offset:35840
    v_lshlrev_b32 v138, 16, v118
    v_and_b32 v139, s72, v118
    v_add_f32 v12, v12, v138
    v_add_f32 v13, v13, v139
    s_add_u32 m0, s45, 18432
    s_add_u32 s53, s46, 688128
    buffer_load_dwordx4 v4, s[16:19], s53 offen lds
    v_mfma_f32_32x32x16_bf16 v[32:47], v[100:103], v[116:119], v[32:47]
    ds_read_b64_tr_b16 v[82:83], v8 offset:36736
    ds_read_b64_tr_b16 v[84:85], v8 offset:35872
    ds_read_b64_tr_b16 v[86:87], v8 offset:36768
    v_fmac_f32 v14, v138, v138
    v_fmac_f32 v15, v139, v139
    v_lshlrev_b32 v140, 16, v119
    v_and_b32 v141, s72, v119
    s_add_u32 m0, s45, 19456
    s_add_u32 s53, s46, 696320
    buffer_load_dwordx4 v4, s[16:19], s53 offen lds
    v_mfma_f32_32x32x16_bf16 v[48:63], v[104:107], v[116:119], v[48:63]
    ds_read_b64_tr_b16 v[88:89], v8 offset:35904
    ds_read_b64_tr_b16 v[90:91], v8 offset:36800
    v_add_f32 v12, v12, v140
    v_add_f32 v13, v13, v141
    v_fmac_f32 v14, v140, v140
    v_fmac_f32 v15, v141, v141
    s_waitcnt lgkmcnt(6)
    s_waitcnt lgkmcnt(4)
    v_mfma_f32_32x32x16_bf16 v[16:31], v[80:83], v[112:115], v[16:31]
    ds_read_b64_tr_b16 v[116:117], v136 offset:28672
    ds_read_b64_tr_b16 v[118:119], v136 offset:29696
    ds_read_b64_tr_b16 v[96:97], v8 offset:39424
    ds_read_b64_tr_b16 v[98:99], v8 offset:40320
    v_lshlrev_b32 v138, 16, v114
    v_and_b32 v139, s72, v114
    v_add_f32 v12, v12, v138
    v_add_f32 v13, v13, v139
    s_add_u32 m0, s45, 20480
    s_add_u32 s53, s46, 704512
    buffer_load_dwordx4 v4, s[16:19], s53 offen lds
    s_waitcnt lgkmcnt(6)
    v_mfma_f32_32x32x16_bf16 v[32:47], v[84:87], v[112:115], v[32:47]
    ds_read_b64_tr_b16 v[100:101], v8 offset:39456
    ds_read_b64_tr_b16 v[102:103], v8 offset:40352
    ds_read_b64_tr_b16 v[104:105], v8 offset:39488
    ds_read_b64_tr_b16 v[106:107], v8 offset:40384
    v_fmac_f32 v14, v138, v138
    v_fmac_f32 v15, v139, v139
    v_lshlrev_b32 v140, 16, v115
    v_and_b32 v141, s72, v115
    s_add_u32 m0, s57, 123008
    s_add_u32 s53, s58, 425984
    buffer_load_dwordx4 v4, s[16:19], s53 offen lds
    s_waitcnt lgkmcnt(8)
    v_mfma_f32_32x32x16_bf16 v[48:63], v[88:91], v[112:115], v[48:63]
    v_add_f32 v12, v12, v140
    v_add_f32 v13, v13, v141
    v_fmac_f32 v14, v140, v140
    v_fmac_f32 v15, v141, v141
    s_waitcnt vmcnt(15) lgkmcnt(0)
    s_barrier
    v_mfma_f32_32x32x16_bf16 v[16:31], v[96:99], v[116:119], v[16:31]
    ds_read_b64_tr_b16 v[112:113], v136 offset:32768
    ds_read_b64_tr_b16 v[114:115], v136 offset:33792
    ds_read_b64_tr_b16 v[80:81], v8 offset:43008
    v_lshlrev_b32 v138, 16, v118
    v_and_b32 v139, s72, v118
    v_add_f32 v12, v12, v138
    v_add_f32 v13, v13, v139
    s_add_u32 m0, s57, 124032
    s_add_u32 s53, s58, 434176
    buffer_load_dwordx4 v4, s[16:19], s53 offen lds
    v_mfma_f32_32x32x16_bf16 v[32:47], v[100:103], v[116:119], v[32:47]
    ds_read_b64_tr_b16 v[82:83], v8 offset:43904
    ds_read_b64_tr_b16 v[84:85], v8 offset:43040
    ds_read_b64_tr_b16 v[86:87], v8 offset:43936
    v_fmac_f32 v14, v138, v138
    v_fmac_f32 v15, v139, v139
    v_lshlrev_b32 v140, 16, v119
    v_and_b32 v141, s72, v119
    s_add_u32 m0, s57, 125056
    s_add_u32 s53, s58, 442368
    buffer_load_dwordx4 v4, s[16:19], s53 offen lds
    v_mfma_f32_32x32x16_bf16 v[48:63], v[104:107], v[116:119], v[48:63]
    ds_read_b64_tr_b16 v[88:89], v8 offset:43072
    ds_read_b64_tr_b16 v[90:91], v8 offset:43968
    v_add_f32 v12, v12, v140
    v_add_f32 v13, v13, v141
    v_fmac_f32 v14, v140, v140
    v_fmac_f32 v15, v141, v141
    s_waitcnt lgkmcnt(6)
    s_waitcnt lgkmcnt(4)
    v_mfma_f32_32x32x16_bf16 v[16:31], v[80:83], v[112:115], v[16:31]
    ds_read_b64_tr_b16 v[116:117], v136 offset:36864
    ds_read_b64_tr_b16 v[118:119], v136 offset:37888
    ds_read_b64_tr_b16 v[96:97], v8 offset:46592
    ds_read_b64_tr_b16 v[98:99], v8 offset:47488
    v_lshlrev_b32 v138, 16, v114
    v_and_b32 v139, s72, v114
    v_add_f32 v12, v12, v138
    v_add_f32 v13, v13, v139
    s_add_u32 m0, s57, 126080
    s_add_u32 s53, s58, 450560
    buffer_load_dwordx4 v4, s[16:19], s53 offen lds
    s_waitcnt lgkmcnt(6)
    v_mfma_f32_32x32x16_bf16 v[32:47], v[84:87], v[112:115], v[32:47]
    ds_read_b64_tr_b16 v[100:101], v8 offset:46624
    ds_read_b64_tr_b16 v[102:103], v8 offset:47520
    ds_read_b64_tr_b16 v[104:105], v8 offset:46656
    ds_read_b64_tr_b16 v[106:107], v8 offset:47552
    v_fmac_f32 v14, v138, v138
    v_fmac_f32 v15, v139, v139
    v_lshlrev_b32 v140, 16, v115
    v_and_b32 v141, s72, v115
    s_add_u32 m0, s45, 28672
    s_add_u32 s53, s46, 1114112
    buffer_load_dwordx4 v4, s[16:19], s53 offen lds
    s_waitcnt lgkmcnt(8)
    v_mfma_f32_32x32x16_bf16 v[48:63], v[88:91], v[112:115], v[48:63]
    v_add_f32 v12, v12, v140
    v_add_f32 v13, v13, v141
    v_fmac_f32 v14, v140, v140
    v_fmac_f32 v15, v141, v141
    s_waitcnt lgkmcnt(0)
    s_barrier
    v_mfma_f32_32x32x16_bf16 v[16:31], v[96:99], v[116:119], v[16:31]
    ds_read_b64_tr_b16 v[112:113], v136 offset:0
    ds_read_b64_tr_b16 v[114:115], v136 offset:1024
    ds_read_b64_tr_b16 v[80:81], v8 offset:50176
    v_lshlrev_b32 v138, 16, v118
    v_and_b32 v139, s72, v118
    v_add_f32 v12, v12, v138
    v_add_f32 v13, v13, v139
    s_add_u32 m0, s45, 29696
    s_add_u32 s53, s46, 1122304
    buffer_load_dwordx4 v4, s[16:19], s53 offen lds
    v_mfma_f32_32x32x16_bf16 v[32:47], v[100:103], v[116:119], v[32:47]
    ds_read_b64_tr_b16 v[82:83], v8 offset:51072
    ds_read_b64_tr_b16 v[84:85], v8 offset:50208
    ds_read_b64_tr_b16 v[86:87], v8 offset:51104
    v_fmac_f32 v14, v138, v138
    v_fmac_f32 v15, v139, v139
    v_lshlrev_b32 v140, 16, v119
    v_and_b32 v141, s72, v119
    s_add_u32 m0, s45, 30720
    s_add_u32 s53, s46, 1130496
    buffer_load_dwordx4 v4, s[16:19], s53 offen lds
    v_mfma_f32_32x32x16_bf16 v[48:63], v[104:107], v[116:119], v[48:63]
    ds_read_b64_tr_b16 v[88:89], v8 offset:50240
    ds_read_b64_tr_b16 v[90:91], v8 offset:51136
    v_add_f32 v12, v12, v140
    v_add_f32 v13, v13, v141
    v_fmac_f32 v14, v140, v140
    v_fmac_f32 v15, v141, v141
    s_waitcnt lgkmcnt(6)
    s_waitcnt lgkmcnt(4)
    v_mfma_f32_32x32x16_bf16 v[16:31], v[80:83], v[112:115], v[16:31]
    ds_read_b64_tr_b16 v[116:117], v136 offset:4096
    ds_read_b64_tr_b16 v[118:119], v136 offset:5120
    ds_read_b64_tr_b16 v[96:97], v8 offset:53760
    ds_read_b64_tr_b16 v[98:99], v8 offset:54656
    v_lshlrev_b32 v138, 16, v114
    v_and_b32 v139, s72, v114
    v_add_f32 v12, v12, v138
    v_add_f32 v13, v13, v139
    s_add_u32 m0, s45, 31744
    s_add_u32 s53, s46, 1138688
    buffer_load_dwordx4 v4, s[16:19], s53 offen lds
    s_waitcnt lgkmcnt(6)
    v_mfma_f32_32x32x16_bf16 v[32:47], v[84:87], v[112:115], v[32:47]
    ds_read_b64_tr_b16 v[100:101], v8 offset:53792
    ds_read_b64_tr_b16 v[102:103], v8 offset:54688
    ds_read_b64_tr_b16 v[104:105], v8 offset:53824
    ds_read_b64_tr_b16 v[106:107], v8 offset:54720
    v_fmac_f32 v14, v138, v138
    v_fmac_f32 v15, v139, v139
    v_lshlrev_b32 v140, 16, v115
    v_and_b32 v141, s72, v115
    s_add_u32 m0, s45, 32768
    s_add_u32 s53, s46, 1146880
    buffer_load_dwordx4 v4, s[16:19], s53 offen lds
    s_waitcnt lgkmcnt(8)
    v_mfma_f32_32x32x16_bf16 v[48:63], v[88:91], v[112:115], v[48:63]
    v_add_f32 v12, v12, v140
    v_add_f32 v13, v13, v141
    v_fmac_f32 v14, v140, v140
    v_fmac_f32 v15, v141, v141
    s_waitcnt lgkmcnt(6)
    s_waitcnt lgkmcnt(4)
    v_mfma_f32_32x32x16_bf16 v[16:31], v[96:99], v[116:119], v[16:31]
    v_lshlrev_b32 v138, 16, v118
    v_and_b32 v139, s72, v118
    v_add_f32 v12, v12, v138
    v_add_f32 v13, v13, v139
    s_add_u32 m0, s45, 33792
    s_add_u32 s53, s46, 1155072
    buffer_load_dwordx4 v4, s[16:19], s53 offen lds
    s_waitcnt lgkmcnt(2)
    v_mfma_f32_32x32x16_bf16 v[32:47], v[100:103], v[116:119], v[32:47]
    v_fmac_f32 v14, v138, v138
    v_fmac_f32 v15, v139, v139
    v_lshlrev_b32 v140, 16, v119
    v_and_b32 v141, s72, v119
    s_add_u32 m0, s45, 34816
    s_add_u32 s53, s46, 1163264
    buffer_load_dwordx4 v4, s[16:19], s53 offen lds
    s_waitcnt lgkmcnt(0)
    v_mfma_f32_32x32x16_bf16 v[48:63], v[104:107], v[116:119], v[48:63]
    v_add_f32 v12, v12, v140
    v_add_f32 v13, v13, v141
    v_fmac_f32 v14, v140, v140
    v_fmac_f32 v15, v141, v141
    v_add_f32 v12, v12, v13
    v_add_f32 v13, v14, v15
    v_mov_b32 v14, v12
    v_mov_b32 v15, v13
    s_nop 0
    v_permlane32_swap_b32 v12, v14
    v_permlane32_swap_b32 v13, v15
    v_add_f32 v12, v12, v14
    v_add_f32 v13, v13, v15
    v_and_b32 v8, 31, v2
    v_lshlrev_b32 v8, 3, v8
    s_lshl_b32 s75, s73, 9
    s_add_u32 s75, s75, 156800
    v_add_u32 v8, s75, v8
    ds_write_b64 v8, v[12:13] offset:256
    s_waitcnt lgkmcnt(0)
    s_barrier
    s_add_u32 m0, s45, 43008
    s_add_u32 s53, s46, 1572864
    buffer_load_dwordx4 v4, s[16:19], s53 offen lds
    s_add_u32 m0, s45, 44032
    s_add_u32 s53, s46, 1581056
    buffer_load_dwordx4 v4, s[16:19], s53 offen lds
    s_add_u32 m0, s45, 45056
    s_add_u32 s53, s46, 1589248
    buffer_load_dwordx4 v4, s[16:19], s53 offen lds
    s_add_u32 m0, s45, 46080
    s_add_u32 s53, s46, 1597440
    buffer_load_dwordx4 v4, s[16:19], s53 offen lds
    s_add_u32 m0, s45, 47104
    s_add_u32 s53, s46, 1605632
    buffer_load_dwordx4 v4, s[16:19], s53 offen lds
    s_add_u32 m0, s45, 48128
    s_add_u32 s53, s46, 1613824
    buffer_load_dwordx4 v4, s[16:19], s53 offen lds
    s_add_u32 m0, s45, 49152
    s_add_u32 s53, s46, 1622016
    buffer_load_dwordx4 v4, s[16:19], s53 offen lds
    s_lshr_b32 s75, s67, 3
    s_lshl_b32 s76, s66, 2
    s_add_u32 s75, s75, s76
    s_lshl_b32 s75, s75, 7
    s_and_b32 s76, s67, 7
    s_lshl_b32 s76, s76, 2
    s_add_u32 s76, s76, s73
    s_lshl_b32 s76, s76, 16
    s_add_u32 s75, s75, s76
    s_add_u32 s75, s75, 4194368
    v_lshrrev_b32 v9, 2, v2
    v_and_b32 v10, 3, v2
    v_lshlrev_b32 v10, 4, v10
    v_lshl_add_u32 v9, v9, 12, v10
    s_lshl_b32 s76, s3, 10
    s_add_u32 m0, s76, 139392
    s_nop 0
    buffer_load_dwordx4 v9, s[4:7], s75 offen sc1 lds
    ds_read_b64 v[14:15], v8 offset:0
    ds_read_b128 v[80:83], v137 offset:0
    ds_read_b128 v[84:87], v137 offset:16
    ds_read_b128 v[88:91], v137 offset:32
    ds_read_b128 v[92:95], v137 offset:48
    s_lshl_b32 s48, s41, 2
    s_add_u32 s48, s48, s73
    s_mul_i32 s48, s48, 112
    s_mul_i32 s49, s40, 7
    s_add_u32 s48, s48, s49
    s_add_u32 s48, s48, 4
    s_lshl_b32 s48, s48, 10
    s_add_u32 s48, s48, 8388608
    s_waitcnt lgkmcnt(4)
    v_add_f32 v12, v12, v14
    v_add_f32 v13, v13, v15
    v_mul_f32 v12, 0x3b000000, v12
    v_mul_f32 v14, 0x3b000000, v13
    v_fma_f32 v14, -v12, v12, v14
    v_max_f32 v14, 0, v14
    v_add_f32 v14, 0x3727c5ac, v14
    v_rsq_f32 v13, v14
    s_nop 0
    v_mul_f32 v8, 0xbfb8aa3b, v13
    v_sub_f32 v12, 0, v12
    ds_read_b128 v[96:99], v137 offset:128
    ds_read_b128 v[100:103], v137 offset:144
    ds_read_b128 v[104:107], v137 offset:160
    ds_read_b128 v[108:111], v137 offset:176
    s_waitcnt lgkmcnt(4)
    v_pk_fma_f32 v[16:17], v[80:81], v[12:13], v[16:17] op_sel_hi:[1,0,1]
    v_pk_fma_f32 v[18:19], v[82:83], v[12:13], v[18:19] op_sel_hi:[1,0,1]
    v_pk_fma_f32 v[20:21], v[84:85], v[12:13], v[20:21] op_sel_hi:[1,0,1]
    v_pk_fma_f32 v[22:23], v[86:87], v[12:13], v[22:23] op_sel_hi:[1,0,1]
    v_pk_fma_f32 v[24:25], v[88:89], v[12:13], v[24:25] op_sel_hi:[1,0,1]
    v_pk_fma_f32 v[26:27], v[90:91], v[12:13], v[26:27] op_sel_hi:[1,0,1]
    v_pk_fma_f32 v[28:29], v[92:93], v[12:13], v[28:29] op_sel_hi:[1,0,1]
    v_pk_fma_f32 v[30:31], v[94:95], v[12:13], v[30:31] op_sel_hi:[1,0,1]
    v_pk_mul_f32 v[112:113], v[16:17], v[8:9] op_sel_hi:[1,0]
    v_pk_mul_f32 v[114:115], v[18:19], v[8:9] op_sel_hi:[1,0]
    v_pk_mul_f32 v[116:117], v[20:21], v[8:9] op_sel_hi:[1,0]
    v_pk_mul_f32 v[118:119], v[22:23], v[8:9] op_sel_hi:[1,0]
    v_exp_f32 v112, v112
    v_exp_f32 v113, v113
    v_exp_f32 v114, v114
    v_exp_f32 v115, v115
    v_exp_f32 v116, v116
    v_exp_f32 v117, v117
    v_exp_f32 v118, v118
    v_exp_f32 v119, v119
    v_pk_mul_f32 v[16:17], v[16:17], v[24:25]
    v_pk_mul_f32 v[18:19], v[18:19], v[26:27]
    v_pk_mul_f32 v[20:21], v[20:21], v[28:29]
    v_pk_mul_f32 v[22:23], v[22:23], v[30:31]
    v_pk_fma_f32 v[112:113], v[112:113], v[14:15], v[14:15] op_sel_hi:[1,0,0]
    v_pk_fma_f32 v[114:115], v[114:115], v[14:15], v[14:15] op_sel_hi:[1,0,0]
    v_pk_fma_f32 v[116:117], v[116:117], v[14:15], v[14:15] op_sel_hi:[1,0,0]
    v_pk_fma_f32 v[118:119], v[118:119], v[14:15], v[14:15] op_sel_hi:[1,0,0]
    v_rcp_f32 v112, v112
    v_rcp_f32 v113, v113
    v_rcp_f32 v114, v114
    v_rcp_f32 v115, v115
    v_rcp_f32 v116, v116
    v_rcp_f32 v117, v117
    v_rcp_f32 v118, v118
    v_rcp_f32 v119, v119
    v_pk_mul_f32 v[16:17], v[16:17], v[112:113]
    v_pk_mul_f32 v[18:19], v[18:19], v[114:115]
    v_pk_mul_f32 v[20:21], v[20:21], v[116:117]
    v_pk_mul_f32 v[22:23], v[22:23], v[118:119]
    v_cvt_pk_bf16_f32 v120, v16, v17
    v_cvt_pk_bf16_f32 v121, v18, v19
    v_cvt_pk_bf16_f32 v122, v20, v21
    v_cvt_pk_bf16_f32 v123, v22, v23
    buffer_store_dwordx4 v[120:123], v3, s[4:7], s48 offen offset:0 sc1
    ds_read_b128 v[80:83], v137 offset:256
    ds_read_b128 v[84:87], v137 offset:272
    ds_read_b128 v[88:91], v137 offset:288
    ds_read_b128 v[92:95], v137 offset:304
    s_waitcnt lgkmcnt(4)
    v_pk_fma_f32 v[32:33], v[96:97], v[12:13], v[32:33] op_sel_hi:[1,0,1]
    v_pk_fma_f32 v[34:35], v[98:99], v[12:13], v[34:35] op_sel_hi:[1,0,1]
    v_pk_fma_f32 v[36:37], v[100:101], v[12:13], v[36:37] op_sel_hi:[1,0,1]
    v_pk_fma_f32 v[38:39], v[102:103], v[12:13], v[38:39] op_sel_hi:[1,0,1]
    v_pk_fma_f32 v[40:41], v[104:105], v[12:13], v[40:41] op_sel_hi:[1,0,1]
    v_pk_fma_f32 v[42:43], v[106:107], v[12:13], v[42:43] op_sel_hi:[1,0,1]
    v_pk_fma_f32 v[44:45], v[108:109], v[12:13], v[44:45] op_sel_hi:[1,0,1]
    v_pk_fma_f32 v[46:47], v[110:111], v[12:13], v[46:47] op_sel_hi:[1,0,1]
    v_pk_mul_f32 v[112:113], v[32:33], v[8:9] op_sel_hi:[1,0]
    v_pk_mul_f32 v[114:115], v[34:35], v[8:9] op_sel_hi:[1,0]
    v_pk_mul_f32 v[116:117], v[36:37], v[8:9] op_sel_hi:[1,0]
    v_pk_mul_f32 v[118:119], v[38:39], v[8:9] op_sel_hi:[1,0]
    v_exp_f32 v112, v112
    v_exp_f32 v113, v113
    v_exp_f32 v114, v114
    v_exp_f32 v115, v115
    v_exp_f32 v116, v116
    v_exp_f32 v117, v117
    v_exp_f32 v118, v118
    v_exp_f32 v119, v119
    v_pk_mul_f32 v[32:33], v[32:33], v[40:41]
    v_pk_mul_f32 v[34:35], v[34:35], v[42:43]
    v_pk_mul_f32 v[36:37], v[36:37], v[44:45]
    v_pk_mul_f32 v[38:39], v[38:39], v[46:47]
    v_pk_fma_f32 v[112:113], v[112:113], v[14:15], v[14:15] op_sel_hi:[1,0,0]
    v_pk_fma_f32 v[114:115], v[114:115], v[14:15], v[14:15] op_sel_hi:[1,0,0]
    v_pk_fma_f32 v[116:117], v[116:117], v[14:15], v[14:15] op_sel_hi:[1,0,0]
    v_pk_fma_f32 v[118:119], v[118:119], v[14:15], v[14:15] op_sel_hi:[1,0,0]
    v_rcp_f32 v112, v112
    v_rcp_f32 v113, v113
    v_rcp_f32 v114, v114
    v_rcp_f32 v115, v115
    v_rcp_f32 v116, v116
    v_rcp_f32 v117, v117
    v_rcp_f32 v118, v118
    v_rcp_f32 v119, v119
    v_pk_mul_f32 v[32:33], v[32:33], v[112:113]
    v_pk_mul_f32 v[34:35], v[34:35], v[114:115]
    v_pk_mul_f32 v[36:37], v[36:37], v[116:117]
    v_pk_mul_f32 v[38:39], v[38:39], v[118:119]
    v_cvt_pk_bf16_f32 v124, v32, v33
    v_cvt_pk_bf16_f32 v125, v34, v35
    v_cvt_pk_bf16_f32 v126, v36, v37
    v_cvt_pk_bf16_f32 v127, v38, v39
    buffer_store_dwordx4 v[124:127], v3, s[4:7], s48 offen offset:1024 sc1
    s_waitcnt lgkmcnt(0)
    v_pk_fma_f32 v[48:49], v[80:81], v[12:13], v[48:49] op_sel_hi:[1,0,1]
    v_pk_fma_f32 v[50:51], v[82:83], v[12:13], v[50:51] op_sel_hi:[1,0,1]
    v_pk_fma_f32 v[52:53], v[84:85], v[12:13], v[52:53] op_sel_hi:[1,0,1]
    v_pk_fma_f32 v[54:55], v[86:87], v[12:13], v[54:55] op_sel_hi:[1,0,1]
    v_pk_fma_f32 v[56:57], v[88:89], v[12:13], v[56:57] op_sel_hi:[1,0,1]
    v_pk_fma_f32 v[58:59], v[90:91], v[12:13], v[58:59] op_sel_hi:[1,0,1]
    v_pk_fma_f32 v[60:61], v[92:93], v[12:13], v[60:61] op_sel_hi:[1,0,1]
    v_pk_fma_f32 v[62:63], v[94:95], v[12:13], v[62:63] op_sel_hi:[1,0,1]
    v_pk_mul_f32 v[112:113], v[48:49], v[8:9] op_sel_hi:[1,0]
    v_pk_mul_f32 v[114:115], v[50:51], v[8:9] op_sel_hi:[1,0]
    v_pk_mul_f32 v[116:117], v[52:53], v[8:9] op_sel_hi:[1,0]
    v_pk_mul_f32 v[118:119], v[54:55], v[8:9] op_sel_hi:[1,0]
    v_exp_f32 v112, v112
    v_exp_f32 v113, v113
    v_exp_f32 v114, v114
    v_exp_f32 v115, v115
    v_exp_f32 v116, v116
    v_exp_f32 v117, v117
    v_exp_f32 v118, v118
    v_exp_f32 v119, v119
    v_pk_mul_f32 v[48:49], v[48:49], v[56:57]
    v_pk_mul_f32 v[50:51], v[50:51], v[58:59]
    v_pk_mul_f32 v[52:53], v[52:53], v[60:61]
    v_pk_mul_f32 v[54:55], v[54:55], v[62:63]
    v_pk_fma_f32 v[112:113], v[112:113], v[14:15], v[14:15] op_sel_hi:[1,0,0]
    v_pk_fma_f32 v[114:115], v[114:115], v[14:15], v[14:15] op_sel_hi:[1,0,0]
    v_pk_fma_f32 v[116:117], v[116:117], v[14:15], v[14:15] op_sel_hi:[1,0,0]
    v_pk_fma_f32 v[118:119], v[118:119], v[14:15], v[14:15] op_sel_hi:[1,0,0]
    v_rcp_f32 v112, v112
    v_rcp_f32 v113, v113
    v_rcp_f32 v114, v114
    v_rcp_f32 v115, v115
    v_rcp_f32 v116, v116
    v_rcp_f32 v117, v117
    v_rcp_f32 v118, v118
    v_rcp_f32 v119, v119
    v_pk_mul_f32 v[48:49], v[48:49], v[112:113]
    v_pk_mul_f32 v[50:51], v[50:51], v[114:115]
    v_pk_mul_f32 v[52:53], v[52:53], v[116:117]
    v_pk_mul_f32 v[54:55], v[54:55], v[118:119]
    v_cvt_pk_bf16_f32 v120, v48, v49
    v_cvt_pk_bf16_f32 v121, v50, v51
    v_cvt_pk_bf16_f32 v122, v52, v53
    v_cvt_pk_bf16_f32 v123, v54, v55
    buffer_store_dwordx4 v[120:123], v3, s[4:7], s48 offen offset:2048 sc1
    s_lshr_b32 s40, s67, 3
    s_lshl_b32 s41, s66, 2
    s_add_u32 s40, s40, s41
    s_lshl_b32 s40, s40, 1
    s_add_u32 s40, s40, 1
    s_mul_i32 s41, s40, 112
    s_mul_i32 s42, s73, 28
    s_add_u32 s41, s41, s42
    s_lshl_b32 s41, s41, 10
    s_add_u32 s41, s41, 8388608
    s_mul_i32 s75, s73, 14336
    v_add_u32 v8, s75, v152
    v_xor_b32 v9, 64, v8
    v_add_u32 v10, 57472, v8
    v_add_u32 v11, 57472, v9
    s_lshl_b32 s75, s73, 12
    s_add_u32 s75, s75, 123008
    v_add_u32 v12, s75, v152
    v_xor_b32 v13, 64, v12
    s_lshl_b32 s75, s73, 11
    s_add_u32 s75, s75, 32768
    v_add_u32 v14, s75, v3
    s_lshl_b32 s75, s73, 13
    s_add_u32 s75, s75, 32768
    v_add_u32 v15, s75, v3
    v_mov_b32 v158, v4
    v_lshrrev_b32 v4, 2, v6
    v_lshrrev_b32 v5, 1, v7
    v_lshl_add_u32 v4, v5, 3, v4
    v_lshlrev_b32 v4, 6, v4
    v_and_b32 v5, 1, v7
    v_lshl_add_u32 v4, v5, 5, v4
    v_and_b32 v5, 3, v6
    v_lshl_add_u32 v4, v5, 3, v4
    s_lshl_b32 s75, s3, 10
    s_add_u32 s75, s75, 139392
    v_add_u32 v4, s75, v4
    v_and_b32 v5, 31, v2
    v_lshlrev_b32 v5, 10, v5
    v_lshrrev_b32 v6, 5, v2
    v_lshl_add_u32 v5, v6, 4, v5
    s_lshl_b32 s43, s40, 15
    s_and_b32 s75, s67, 7
    s_lshl_b32 s75, s75, 7
    s_add_u32 s43, s43, s75
    s_lshl_b32 s75, s73, 5
    s_add_u32 s43, s43, s75
    s_waitcnt vmcnt(4)
    s_barrier
    ds_read_b64_tr_b16 a[0:1], v8 offset:0
    ds_read_b64_tr_b16 a[2:3], v8 offset:512
    ds_read_b64_tr_b16 a[4:5], v9 offset:0
    ds_read_b64_tr_b16 a[6:7], v9 offset:512
    ds_read_b64_tr_b16 a[8:9], v8 offset:2048
    ds_read_b64_tr_b16 a[10:11], v8 offset:2560
    ds_read_b64_tr_b16 a[12:13], v9 offset:2048
    ds_read_b64_tr_b16 a[14:15], v9 offset:2560
    ds_read_b64_tr_b16 a[16:17], v8 offset:4096
    ds_read_b64_tr_b16 a[18:19], v8 offset:4608
    ds_read_b64_tr_b16 a[20:21], v9 offset:4096
    ds_read_b64_tr_b16 a[22:23], v9 offset:4608
    ds_read_b64_tr_b16 a[24:25], v8 offset:6144
    ds_read_b64_tr_b16 a[26:27], v8 offset:6656
    ds_read_b64_tr_b16 a[28:29], v9 offset:6144
    ds_read_b64_tr_b16 a[30:31], v9 offset:6656
    ds_read_b64_tr_b16 a[32:33], v8 offset:8192
    ds_read_b64_tr_b16 a[34:35], v8 offset:8704
    ds_read_b64_tr_b16 a[36:37], v9 offset:8192
    ds_read_b64_tr_b16 a[38:39], v9 offset:8704
    ds_read_b64_tr_b16 a[40:41], v8 offset:10240
    ds_read_b64_tr_b16 a[42:43], v8 offset:10752
    ds_read_b64_tr_b16 a[44:45], v9 offset:10240
    ds_read_b64_tr_b16 a[46:47], v9 offset:10752
    ds_read_b64_tr_b16 a[48:49], v8 offset:12288
    ds_read_b64_tr_b16 a[50:51], v8 offset:12800
    ds_read_b64_tr_b16 a[52:53], v9 offset:12288
    ds_read_b64_tr_b16 a[54:55], v9 offset:12800
    ds_read_b64_tr_b16 a[56:57], v10 offset:0
    ds_read_b64_tr_b16 a[58:59], v10 offset:512
    ds_read_b64_tr_b16 a[60:61], v11 offset:0
    ds_read_b64_tr_b16 a[62:63], v11 offset:512
    ds_read_b64_tr_b16 a[64:65], v10 offset:2048
    ds_read_b64_tr_b16 a[66:67], v10 offset:2560
    ds_read_b64_tr_b16 a[68:69], v11 offset:2048
    ds_read_b64_tr_b16 a[70:71], v11 offset:2560
    ds_read_b64_tr_b16 a[72:73], v10 offset:4096
    ds_read_b64_tr_b16 a[74:75], v10 offset:4608
    ds_read_b64_tr_b16 a[76:77], v11 offset:4096
    ds_read_b64_tr_b16 a[78:79], v11 offset:4608
    ds_read_b64_tr_b16 a[80:81], v10 offset:6144
    ds_read_b64_tr_b16 a[82:83], v10 offset:6656
    ds_read_b64_tr_b16 a[84:85], v11 offset:6144
    ds_read_b64_tr_b16 a[86:87], v11 offset:6656
    ds_read_b64_tr_b16 a[88:89], v10 offset:8192
    ds_read_b64_tr_b16 a[90:91], v10 offset:8704
    ds_read_b64_tr_b16 a[92:93], v11 offset:8192
    ds_read_b64_tr_b16 a[94:95], v11 offset:8704
    s_mul_i32 s45, s73, 14336
    s_mul_i32 s46, s73, 458752
    s_waitcnt vmcnt(0) lgkmcnt(0)
    s_barrier
    s_add_u32 m0, s45, 12288
    s_add_u32 s53, s46, 98304
    buffer_load_dwordx4 v158, s[16:19], s53 offen lds
    s_add_u32 m0, s45, 13312
    s_add_u32 s53, s46, 106496
    buffer_load_dwordx4 v158, s[16:19], s53 offen lds
    s_add_u32 m0, s45, 57472
    s_add_u32 s53, s46, 114688
    buffer_load_dwordx4 v158, s[16:19], s53 offen lds
    s_add_u32 m0, s45, 58496
    s_add_u32 s53, s46, 122880
    buffer_load_dwordx4 v158, s[16:19], s53 offen lds
    s_add_u32 m0, s45, 59520
    s_add_u32 s53, s46, 131072
    buffer_load_dwordx4 v158, s[16:19], s53 offen lds
    s_add_u32 m0, s45, 60544
    s_add_u32 s53, s46, 139264
    buffer_load_dwordx4 v158, s[16:19], s53 offen lds
    s_add_u32 m0, s45, 61568
    s_add_u32 s53, s46, 147456
    buffer_load_dwordx4 v158, s[16:19], s53 offen lds
    s_add_u32 m0, s45, 62592
    s_add_u32 s53, s46, 155648
    buffer_load_dwordx4 v158, s[16:19], s53 offen lds
    s_add_u32 m0, s45, 63616
    s_add_u32 s53, s46, 163840
    buffer_load_dwordx4 v158, s[16:19], s53 offen lds
    s_add_u32 m0, s45, 64640
    s_add_u32 s53, s46, 172032
    buffer_load_dwordx4 v158, s[16:19], s53 offen lds
    s_add_u32 m0, s45, 65664
    s_add_u32 s53, s46, 180224
    buffer_load_dwordx4 v158, s[16:19], s53 offen lds
    s_add_u32 m0, s45, 66688
    s_add_u32 s53, s46, 188416
    buffer_load_dwordx4 v158, s[16:19], s53 offen lds
    s_waitcnt vmcnt(0)
    s_barrier
    s_add_u32 s53, s41, 24576
    buffer_load_dwordx4 v[64:67], v3, s[4:7], s53 offen offset:0 sc1
    buffer_load_dwordx4 v[68:71], v3, s[4:7], s53 offen offset:1024 sc1
    buffer_load_dwordx4 v[72:75], v3, s[4:7], s53 offen offset:2048 sc1
    buffer_load_dwordx4 v[76:79], v3, s[4:7], s53 offen offset:3072 sc1
    s_add_u32 s53, s41, 0
    buffer_load_dwordx4 v[80:83], v3, s[4:7], s53 offen offset:0 sc1
    buffer_load_dwordx4 v[84:87], v3, s[4:7], s53 offen offset:1024 sc1
    ds_read_b64_tr_b16 v[48:49], v10 offset:10240
    ds_read_b64_tr_b16 v[50:51], v10 offset:10752
    ds_read_b64_tr_b16 v[52:53], v11 offset:10240
    ds_read_b64_tr_b16 v[54:55], v11 offset:10752
    ds_read_b64_tr_b16 v[56:57], v10 offset:12288
    ds_read_b64_tr_b16 v[58:59], v10 offset:12800
    ds_read_b64_tr_b16 v[60:61], v11 offset:12288
    ds_read_b64_tr_b16 v[62:63], v11 offset:12800
    s_waitcnt vmcnt(5)
    s_waitcnt lgkmcnt(4)
    v_mfma_f32_32x32x16_bf16 v[16:31], v[48:51], v[64:67], 0
    v_mfma_f32_32x32x16_bf16 v[32:47], v[52:55], v[64:67], 0
    s_add_u32 s53, s41, 0
    buffer_load_dwordx4 v[64:67], v3, s[4:7], s53 offen offset:2048 sc1
    ds_read_b64_tr_b16 v[48:49], v12 offset:0
    ds_read_b64_tr_b16 v[50:51], v12 offset:512
    ds_read_b64_tr_b16 v[52:53], v13 offset:0
    ds_read_b64_tr_b16 v[54:55], v13 offset:512
    s_waitcnt vmcnt(5)
    s_waitcnt lgkmcnt(4)
    v_mfma_f32_32x32x16_bf16 v[16:31], v[56:59], v[68:71], v[16:31]
    v_mfma_f32_32x32x16_bf16 v[32:47], v[60:63], v[68:71], v[32:47]
    s_add_u32 s53, s41, 0
    buffer_load_dwordx4 v[68:71], v3, s[4:7], s53 offen offset:3072 sc1
    ds_read_b64_tr_b16 v[56:57], v12 offset:2048
    ds_read_b64_tr_b16 v[58:59], v12 offset:2560
    ds_read_b64_tr_b16 v[60:61], v13 offset:2048
    ds_read_b64_tr_b16 v[62:63], v13 offset:2560
    s_waitcnt vmcnt(5)
    s_waitcnt lgkmcnt(4)
    v_mfma_f32_32x32x16_bf16 v[16:31], v[48:51], v[72:75], v[16:31]
    v_mfma_f32_32x32x16_bf16 v[32:47], v[52:55], v[72:75], v[32:47]
    s_add_u32 s53, s41, 4096
    buffer_load_dwordx4 v[72:75], v3, s[4:7], s53 offen offset:0 sc1
    ds_read_b64_tr_b16 v[48:49], v8 offset:0
    ds_read_b64_tr_b16 v[50:51], v8 offset:512
    ds_read_b64_tr_b16 v[52:53], v9 offset:0
    ds_read_b64_tr_b16 v[54:55], v9 offset:512
    s_waitcnt vmcnt(5)
    s_waitcnt lgkmcnt(4)
    v_mfma_f32_32x32x16_bf16 v[16:31], v[56:59], v[76:79], v[16:31]
    v_mfma_f32_32x32x16_bf16 v[32:47], v[60:63], v[76:79], v[32:47]
    s_add_u32 s53, s41, 4096
    buffer_load_dwordx4 v[76:79], v3, s[4:7], s53 offen offset:1024 sc1
    ds_read_b64_tr_b16 v[56:57], v8 offset:2048
    ds_read_b64_tr_b16 v[58:59], v8 offset:2560
    ds_read_b64_tr_b16 v[60:61], v9 offset:2048
    ds_read_b64_tr_b16 v[62:63], v9 offset:2560
    s_waitcnt vmcnt(5)
    s_waitcnt lgkmcnt(4)
    v_mfma_f32_32x32x16_bf16 v[16:31], v[48:51], v[80:83], v[16:31]
    v_mfma_f32_32x32x16_bf16 v[32:47], v[52:55], v[80:83], v[32:47]
    s_add_u32 s53, s41, 4096
    buffer_load_dwordx4 v[80:83], v3, s[4:7], s53 offen offset:2048 sc1
    ds_read_b64_tr_b16 v[48:49], v8 offset:4096
    ds_read_b64_tr_b16 v[50:51], v8 offset:4608
    ds_read_b64_tr_b16 v[52:53], v9 offset:4096
    ds_read_b64_tr_b16 v[54:55], v9 offset:4608
    s_waitcnt vmcnt(5)
    s_waitcnt lgkmcnt(4)
    v_mfma_f32_32x32x16_bf16 v[16:31], v[56:59], v[84:87], v[16:31]
    v_mfma_f32_32x32x16_bf16 v[32:47], v[60:63], v[84:87], v[32:47]
    s_add_u32 s53, s41, 4096
    buffer_load_dwordx4 v[84:87], v3, s[4:7], s53 offen offset:3072 sc1
    ds_read_b64_tr_b16 v[56:57], v8 offset:6144
    ds_read_b64_tr_b16 v[58:59], v8 offset:6656
    ds_read_b64_tr_b16 v[60:61], v9 offset:6144
    ds_read_b64_tr_b16 v[62:63], v9 offset:6656
    s_waitcnt vmcnt(5)
    s_waitcnt lgkmcnt(4)
    v_mfma_f32_32x32x16_bf16 v[16:31], v[48:51], v[64:67], v[16:31]
    v_mfma_f32_32x32x16_bf16 v[32:47], v[52:55], v[64:67], v[32:47]
    s_add_u32 s53, s41, 8192
    buffer_load_dwordx4 v[64:67], v3, s[4:7], s53 offen offset:0 sc1
    ds_read_b64_tr_b16 v[48:49], v8 offset:8192
    ds_read_b64_tr_b16 v[50:51], v8 offset:8704
    ds_read_b64_tr_b16 v[52:53], v9 offset:8192
    ds_read_b64_tr_b16 v[54:55], v9 offset:8704
    s_waitcnt vmcnt(5)
    s_waitcnt lgkmcnt(4)
    v_mfma_f32_32x32x16_bf16 v[16:31], v[56:59], v[68:71], v[16:31]
    v_mfma_f32_32x32x16_bf16 v[32:47], v[60:63], v[68:71], v[32:47]
    s_add_u32 s53, s41, 8192
    buffer_load_dwordx4 v[68:71], v3, s[4:7], s53 offen offset:1024 sc1
    ds_read_b64_tr_b16 v[56:57], v8 offset:10240
    ds_read_b64_tr_b16 v[58:59], v8 offset:10752
    ds_read_b64_tr_b16 v[60:61], v9 offset:10240
    ds_read_b64_tr_b16 v[62:63], v9 offset:10752
    s_waitcnt vmcnt(5)
    s_waitcnt lgkmcnt(4)
    v_mfma_f32_32x32x16_bf16 v[16:31], v[48:51], v[72:75], v[16:31]
    v_mfma_f32_32x32x16_bf16 v[32:47], v[52:55], v[72:75], v[32:47]
    s_add_u32 s53, s41, 8192
    buffer_load_dwordx4 v[72:75], v3, s[4:7], s53 offen offset:2048 sc1
    ds_read_b64_tr_b16 v[48:49], v8 offset:12288
    ds_read_b64_tr_b16 v[50:51], v8 offset:12800
    ds_read_b64_tr_b16 v[52:53], v9 offset:12288
    ds_read_b64_tr_b16 v[54:55], v9 offset:12800
    s_waitcnt vmcnt(5)
    s_waitcnt lgkmcnt(4)
    v_mfma_f32_32x32x16_bf16 v[16:31], v[56:59], v[76:79], v[16:31]
    v_mfma_f32_32x32x16_bf16 v[32:47], v[60:63], v[76:79], v[32:47]
    s_add_u32 s53, s41, 8192
    buffer_load_dwordx4 v[76:79], v3, s[4:7], s53 offen offset:3072 sc1
    ds_read_b64_tr_b16 v[56:57], v10 offset:0
    ds_read_b64_tr_b16 v[58:59], v10 offset:512
    ds_read_b64_tr_b16 v[60:61], v11 offset:0
    ds_read_b64_tr_b16 v[62:63], v11 offset:512
    s_waitcnt vmcnt(5)
    s_waitcnt lgkmcnt(4)
    v_mfma_f32_32x32x16_bf16 v[16:31], v[48:51], v[80:83], v[16:31]
    v_mfma_f32_32x32x16_bf16 v[32:47], v[52:55], v[80:83], v[32:47]
    s_add_u32 s53, s41, 12288
    buffer_load_dwordx4 v[80:83], v3, s[4:7], s53 offen offset:0 sc1
    ds_read_b64_tr_b16 v[48:49], v10 offset:2048
    ds_read_b64_tr_b16 v[50:51], v10 offset:2560
    ds_read_b64_tr_b16 v[52:53], v11 offset:2048
    ds_read_b64_tr_b16 v[54:55], v11 offset:2560
    s_waitcnt vmcnt(5)
    s_waitcnt lgkmcnt(4)
    v_mfma_f32_32x32x16_bf16 v[16:31], v[56:59], v[84:87], v[16:31]
    v_mfma_f32_32x32x16_bf16 v[32:47], v[60:63], v[84:87], v[32:47]
    s_add_u32 s53, s41, 12288
    buffer_load_dwordx4 v[84:87], v3, s[4:7], s53 offen offset:1024 sc1
    ds_read_b64_tr_b16 v[56:57], v10 offset:4096
    ds_read_b64_tr_b16 v[58:59], v10 offset:4608
    ds_read_b64_tr_b16 v[60:61], v11 offset:4096
    ds_read_b64_tr_b16 v[62:63], v11 offset:4608
    s_waitcnt vmcnt(5)
    s_waitcnt lgkmcnt(4)
    v_mfma_f32_32x32x16_bf16 v[16:31], v[48:51], v[64:67], v[16:31]
    v_mfma_f32_32x32x16_bf16 v[32:47], v[52:55], v[64:67], v[32:47]
    s_add_u32 s53, s41, 12288
    buffer_load_dwordx4 v[64:67], v3, s[4:7], s53 offen offset:2048 sc1
    ds_read_b64_tr_b16 v[48:49], v10 offset:6144
    ds_read_b64_tr_b16 v[50:51], v10 offset:6656
    ds_read_b64_tr_b16 v[52:53], v11 offset:6144
    ds_read_b64_tr_b16 v[54:55], v11 offset:6656
    s_waitcnt vmcnt(5)
    s_waitcnt lgkmcnt(4)
    v_mfma_f32_32x32x16_bf16 v[16:31], v[56:59], v[68:71], v[16:31]
    v_mfma_f32_32x32x16_bf16 v[32:47], v[60:63], v[68:71], v[32:47]
    s_add_u32 s53, s41, 12288
    buffer_load_dwordx4 v[68:71], v3, s[4:7], s53 offen offset:3072 sc1
    ds_read_b64_tr_b16 v[56:57], v10 offset:8192
    ds_read_b64_tr_b16 v[58:59], v10 offset:8704
    ds_read_b64_tr_b16 v[60:61], v11 offset:8192
    ds_read_b64_tr_b16 v[62:63], v11 offset:8704
    s_waitcnt vmcnt(5)
    s_waitcnt lgkmcnt(4)
    v_mfma_f32_32x32x16_bf16 v[16:31], v[48:51], v[72:75], v[16:31]
    v_mfma_f32_32x32x16_bf16 v[32:47], v[52:55], v[72:75], v[32:47]
    s_add_u32 s53, s41, 16384
    buffer_load_dwordx4 v[72:75], v3, s[4:7], s53 offen offset:0 sc1
    s_waitcnt vmcnt(5)
    s_waitcnt lgkmcnt(0)
    v_mfma_f32_32x32x16_bf16 v[16:31], v[56:59], v[76:79], v[16:31]
    v_mfma_f32_32x32x16_bf16 v[32:47], v[60:63], v[76:79], v[32:47]
    s_add_u32 s53, s41, 16384
    buffer_load_dwordx4 v[76:79], v3, s[4:7], s53 offen offset:1024 sc1
    ds_read_b64_tr_b16 v[56:57], v4 offset:0
    ds_read_b64_tr_b16 v[58:59], v4 offset:256
    s_waitcnt vmcnt(5)
    v_mfma_f32_32x32x16_bf16 v[16:31], a[0:3], v[80:83], v[16:31]
    v_mfma_f32_32x32x16_bf16 v[32:47], a[4:7], v[80:83], v[32:47]
    s_add_u32 s53, s41, 16384
    buffer_load_dwordx4 v[80:83], v3, s[4:7], s53 offen offset:2048 sc1
    s_waitcnt vmcnt(5)
    v_mfma_f32_32x32x16_bf16 v[16:31], a[8:11], v[84:87], v[16:31]
    v_mfma_f32_32x32x16_bf16 v[32:47], a[12:15], v[84:87], v[32:47]
    s_add_u32 s53, s41, 16384
    buffer_load_dwordx4 v[84:87], v3, s[4:7], s53 offen offset:3072 sc1
    s_waitcnt vmcnt(5)
    s_barrier
    v_mfma_f32_32x32x16_bf16 v[16:31], a[16:19], v[64:67], v[16:31]
    v_mfma_f32_32x32x16_bf16 v[32:47], a[20:23], v[64:67], v[32:47]
    s_add_u32 s53, s41, 20480
    buffer_load_dwordx4 v[64:67], v3, s[4:7], s53 offen offset:0 sc1
    s_waitcnt vmcnt(5)
    v_mfma_f32_32x32x16_bf16 v[16:31], a[24:27], v[68:71], v[16:31]
    v_mfma_f32_32x32x16_bf16 v[32:47], a[28:31], v[68:71], v[32:47]
    s_add_u32 s53, s41, 20480
    buffer_load_dwordx4 v[68:71], v3, s[4:7], s53 offen offset:1024 sc1
    s_waitcnt vmcnt(5)
    v_mfma_f32_32x32x16_bf16 v[16:31], a[32:35], v[72:75], v[16:31]
    v_mfma_f32_32x32x16_bf16 v[32:47], a[36:39], v[72:75], v[32:47]
    s_waitcnt lgkmcnt(0)
    v_lshlrev_b32 v48, 16, v56
    v_and_b32 v49, s72, v56
    v_lshlrev_b32 v50, 16, v57
    v_and_b32 v51, s72, v57
    v_lshlrev_b32 v52, 16, v58
    v_and_b32 v53, s72, v58
    v_lshlrev_b32 v54, 16, v59
    v_and_b32 v55, s72, v59
    s_add_u32 s53, s41, 20480
    buffer_load_dwordx4 v[72:75], v3, s[4:7], s53 offen offset:2048 sc1
    s_waitcnt vmcnt(5)
    v_mfma_f32_32x32x16_bf16 v[16:31], a[40:43], v[76:79], v[16:31]
    v_mfma_f32_32x32x16_bf16 v[32:47], a[44:47], v[76:79], v[32:47]
    s_add_u32 s53, s41, 20480
    buffer_load_dwordx4 v[76:79], v3, s[4:7], s53 offen offset:3072 sc1
    s_waitcnt vmcnt(5)
    v_mfma_f32_32x32x16_bf16 v[16:31], a[48:51], v[80:83], v[16:31]
    v_mfma_f32_32x32x16_bf16 v[32:47], a[52:55], v[80:83], v[32:47]
    s_waitcnt vmcnt(4)
    v_mfma_f32_32x32x16_bf16 v[16:31], a[56:59], v[84:87], v[16:31]
    v_mfma_f32_32x32x16_bf16 v[32:47], a[60:63], v[84:87], v[32:47]
    s_waitcnt vmcnt(3)
    v_mfma_f32_32x32x16_bf16 v[16:31], a[64:67], v[64:67], v[16:31]
    v_mfma_f32_32x32x16_bf16 v[32:47], a[68:71], v[64:67], v[32:47]
    s_waitcnt vmcnt(2)
    v_mfma_f32_32x32x16_bf16 v[16:31], a[72:75], v[68:71], v[16:31]
    v_mfma_f32_32x32x16_bf16 v[32:47], a[76:79], v[68:71], v[32:47]
    s_waitcnt vmcnt(1)
    v_mfma_f32_32x32x16_bf16 v[16:31], a[80:83], v[72:75], v[16:31]
    v_mfma_f32_32x32x16_bf16 v[32:47], a[84:87], v[72:75], v[32:47]
    s_waitcnt vmcnt(0)
    v_mfma_f32_32x32x16_bf16 v[16:31], a[88:91], v[76:79], v[16:31]
    v_mfma_f32_32x32x16_bf16 v[32:47], a[92:95], v[76:79], v[32:47]
    s_nop 10
    ds_write_b128 v14, v[16:19] offset:0
    ds_write_b128 v14, v[20:23] offset:1024
    ds_write_b128 v14, v[24:27] offset:8192
    ds_write_b128 v14, v[28:31] offset:9216
    ds_write_b128 v14, v[32:35] offset:16384
    ds_write_b128 v14, v[36:39] offset:17408
    ds_write_b128 v14, v[40:43] offset:24576
    ds_write_b128 v14, v[44:47] offset:25600
    s_waitcnt lgkmcnt(0)
    s_barrier
    ds_read_b128 v[96:99], v15 offset:0
    ds_read_b128 v[100:103], v15 offset:1024
    ds_read_b128 v[104:107], v15 offset:2048
    ds_read_b128 v[108:111], v15 offset:3072
    ds_read_b128 v[112:115], v15 offset:4096
    ds_read_b128 v[116:119], v15 offset:5120
    ds_read_b128 v[120:123], v15 offset:6144
    ds_read_b128 v[124:127], v15 offset:7168
    s_waitcnt lgkmcnt(6)
    v_pk_add_f32 v[48:49], v[48:49], v[96:97]
    v_pk_add_f32 v[50:51], v[50:51], v[98:99]
    v_pk_add_f32 v[52:53], v[52:53], v[100:101]
    v_pk_add_f32 v[54:55], v[54:55], v[102:103]
    s_waitcnt lgkmcnt(4)
    v_pk_add_f32 v[48:49], v[48:49], v[104:105]
    v_pk_add_f32 v[50:51], v[50:51], v[106:107]
    v_pk_add_f32 v[52:53], v[52:53], v[108:109]
    v_pk_add_f32 v[54:55], v[54:55], v[110:111]
    s_waitcnt lgkmcnt(2)
    v_pk_add_f32 v[48:49], v[48:49], v[112:113]
    v_pk_add_f32 v[50:51], v[50:51], v[114:115]
    v_pk_add_f32 v[52:53], v[52:53], v[116:117]
    v_pk_add_f32 v[54:55], v[54:55], v[118:119]
    s_waitcnt lgkmcnt(0)
    v_pk_add_f32 v[48:49], v[48:49], v[120:121]
    v_pk_add_f32 v[50:51], v[50:51], v[122:123]
    v_pk_add_f32 v[52:53], v[52:53], v[124:125]
    v_pk_add_f32 v[54:55], v[54:55], v[126:127]
    v_cvt_pk_bf16_f32 v56, v48, v49
    v_cvt_pk_bf16_f32 v57, v50, v51
    v_cvt_pk_bf16_f32 v58, v52, v53
    v_cvt_pk_bf16_f32 v59, v54, v55
    buffer_store_dwordx4 v[56:59], v5, s[20:23], s43 offen
    s_endpgm
k_end:
.section .rodata,"a"
.p2align 6
.amdhsa_kernel sequential_preLN__ssm_conv_h3__glu_gated_swiglu__prompt_kernel
  .amdhsa_next_free_vgpr 256
  .amdhsa_next_free_sgpr 102
  .amdhsa_accum_offset 160
  .amdhsa_group_segment_fixed_size 0
  .amdhsa_kernarg_size 104
  .amdhsa_user_sgpr_count 2
  .amdhsa_user_sgpr_kernarg_segment_ptr 1
  .amdhsa_system_sgpr_workgroup_id_x 1
  .amdhsa_float_denorm_mode_32 3
.end_amdhsa_kernel
```
